```python
import torch

def _softmax(x, axis=-1):
    return torch.softmax(x, dim=axis)
def _gelu(x):
    return torch.nn.functional.gelu(x, approximate="tanh")
def _silu(x):
    return torch.nn.functional.silu(x)
def _sigmoid(x):
    return torch.sigmoid(x)
def _layernorm(x, axis=-1, eps=1e-5):
    m = x.mean(dim=axis, keepdim=True)
    v = x.var(dim=axis, keepdim=True, unbiased=False)
    return (x - m) / torch.sqrt(v + eps)
def _scatter_add(tgt, idx, src, axis=0):
    return tgt.clone().index_add_(axis, idx, src)
def _segment_sum(src, seg, n):
    out = torch.zeros((n,) + src.shape[1:], dtype=src.dtype)
    return out.index_add_(0, seg, src)
def _pad(x, pw):
    flat = tuple(v for pair in reversed(pw) for v in pair)
    return torch.nn.functional.pad(x, flat)

kernel_name = 'parallel_sum__ssm_conv_s4__glu_gated_swiglu__prompt'

def setup_inputs():

    _w = (lambda a: (lambda t: t.to(torch.bfloat16) if t.is_floating_point() else t)(torch.as_tensor(a)))
    def _A_setup():
        B, L, D, N = 1, 2048, 640, 192
        A_re = -(lambda _x: torch.exp(torch.as_tensor(_x)))((lambda *s: torch.randn(*s, dtype=torch.bfloat16) * 6.4)(D, N))
        A_im = torch.pi * (lambda *s: torch.randn(*s, dtype=torch.bfloat16) * 0.05)(D, N)
        B_re = (lambda *s: torch.randn(*s, dtype=torch.bfloat16) * 0.1)(D, N)
        B_im = (lambda *s: torch.randn(*s, dtype=torch.bfloat16) * 0.1)(D, N)
        C_re = (lambda *s: torch.randn(*s, dtype=torch.bfloat16) * 0.1)(D, N)
        C_im = (lambda *s: torch.randn(*s, dtype=torch.bfloat16) * 0.1)(D, N)
        log_dt = (lambda *s: torch.randn(*s, dtype=torch.bfloat16) * 0.05)(D) * 0.5 - 4.0
        Dskip = (lambda *s: torch.randn(*s, dtype=torch.bfloat16) * 0.05)(D)
        return {
            "u": _w((lambda *s: torch.randn(*s, dtype=torch.bfloat16) * 0.05)(B, L, D)),
            "A_re": _w(A_re),
            "A_im": _w(A_im),
            "B_re": _w(B_re),
            "B_im": _w(B_im),
            "C_re": _w(C_re),
            "C_im": _w(C_im),
            "log_dt": _w(log_dt),
            "Dskip": _w(Dskip),
        }
    _A_in = _A_setup()

    def _B_setup():
        B, S, D, F = 1, 2048, 640, 1536
        return {
            "x": _w((lambda *s: torch.randn(*s, dtype=torch.bfloat16) * 0.05)(B, S, D)),
            "w1": _w((lambda *s: torch.randn(*s, dtype=torch.bfloat16) * 0.4)(D, F) * (2.0 / D) ** 0.5),
            "w3": _w((lambda *s: torch.randn(*s, dtype=torch.bfloat16) * 0.4)(D, F) * (2.0 / D) ** 0.5),
            "w2": _w((lambda *s: torch.randn(*s, dtype=torch.bfloat16) * 0.4)(F, D) * (2.0 / F) ** 0.5),
        }
    _B_in = _B_setup()

    return {
        "A_u": _A_in["u"],
        "A_A_re": _A_in["A_re"],
        "A_A_im": _A_in["A_im"],
        "A_B_re": _A_in["B_re"],
        "A_B_im": _A_in["B_im"],
        "A_C_re": _A_in["C_re"],
        "A_C_im": _A_in["C_im"],
        "A_log_dt": _A_in["log_dt"],
        "A_Dskip": _A_in["Dskip"],
        "B_x": _B_in["x"],
        "B_w1": _B_in["w1"],
        "B_w3": _B_in["w3"],
        "B_w2": _B_in["w2"],
    }

def reference(A_u, A_A_re, A_A_im, A_B_re, A_B_im, A_C_re, A_C_im, A_log_dt, A_Dskip, B_x, B_w1, B_w3, B_w2):
    def _A_ref(u, A_re, A_im, B_re, B_im, C_re, C_im, log_dt, Dskip):
        Bsz, L, D = u.shape
        dt = torch.exp(log_dt)[:, None]
        A = A_re + 1j * A_im
        Bc = B_re + 1j * B_im
        Cc = C_re + 1j * C_im
        logdA = dt * A
        dB = dt * Bc
        l = (lambda x, dt: x.to(dt))(torch.arange(L), A_re.dtype)
        P = torch.exp(logdA[:, :, None] * l[None, None, :])
        K = torch.einsum("dn,dnl,dn->dl", Cc, P, dB).real
        L2 = 2 * L
        Kp = _pad(K, ((0, 0), (0, L)))
        up = (lambda x, *d: x.permute(*d))(u, 0, 2, 1)
        up = _pad(up, ((0, 0), (0, 0), (0, L)))
        Kf = (lambda x, axes=(-2,-1): torch.fft.rfft2(x.float(), dim=axes))(Kp[:, None, :], axes=(-2, -1))
        Uf = (lambda x, axes=(-2,-1): torch.fft.rfft2(x.float(), dim=axes))(up[:, :, None, :], axes=(-2, -1))
        Yf = Uf * Kf[None, :, :, :]
        y = (lambda x, s, axes=(-2,-1): torch.fft.irfft2(x, s=s, dim=axes).to(torch.bfloat16))(Yf, (1, L2), axes=(-2, -1))[:, :, 0, :L]
        y = (lambda x, *d: x.permute(*d))(y, 0, 2, 1) + u * Dskip[None, None, :]
        return y

    def _B_ref(x, w1, w3, w2):
        gate = torch.einsum("bsd,df->bsf", x, w1)
        up = torch.einsum("bsd,df->bsf", x, w3)
        h = _silu(gate) * up
        out = torch.einsum("bsf,fd->bsd", h, w2)
        return out

    x = A_u
    xn = _layernorm(x, axis=-1)
    return x + _A_ref(xn, A_A_re, A_A_im, A_B_re, A_B_im, A_C_re, A_C_im, A_log_dt, A_Dskip) + _B_ref(xn, B_w1, B_w3, B_w2)
```

```asm
; @launch grid=(512,1,1) block=(256,1,1) lds=81920
.amdgcn_target "amdgcn-amd-amdhsa--gfx950"
.text
.globl parallel_sum__ssm_conv_s4__glu_gated_swiglu__prompt_kernel
.p2align 8
.type parallel_sum__ssm_conv_s4__glu_gated_swiglu__prompt_kernel,@function
parallel_sum__ssm_conv_s4__glu_gated_swiglu__prompt_kernel:
    s_getpc_b64 s[98:99]
k_start:
    s_cmp_ge_u32 s2, 512
    s_cbranch_scc1 k_end
    s_cmp_eq_u32 s2, 0
    s_cbranch_scc0 k_nonn
    v_readfirstlane_b32 s20, v0
    s_nop 2
    s_cmp_eq_u32 s20, 0
    s_cbranch_scc0 k_nonn
    s_load_dwordx2 s[20:21], s[0:1], 112
    s_memrealtime s[22:23]
    s_waitcnt lgkmcnt(0)
    s_or_b32 s22, s22, 1
    v_mov_b32 v13, s22
    v_mov_b32 v14, 0
    global_store_dword v14, v13, s[20:21] sc1
k_nonn:
    s_cmp_lt_u32 s2, 256
    s_cbranch_scc0 k_g
    s_mov_b32 s3, s2
    s_load_dwordx16 s[4:19], s[0:1], 8
    v_lshrrev_b32 v2, 6, v0
    s_and_b32 s65, s3, 7
    v_readfirstlane_b32 s61, v2
    s_lshr_b32 s66, s3, 3
    s_mul_i32 s60, s65, 80
    s_lshr_b32 s63, s66, 1
    s_mul_i32 s63, s63, 5
    s_add_u32 s60, s60, s63
    s_and_b32 s62, s66, 1
    s_mul_i32 s63, s62, 3
    s_add_u32 s60, s60, s63
    s_add_u32 s60, s60, s61
    s_sub_u32 s62, 3, s62
    v_and_b32 v1, 63, v0
    s_cmp_ge_u32 s61, s62
    s_cbranch_scc1 c_nopar
    s_mul_i32 s20, s60, 384
    v_lshlrev_b32 v2, 1, v1
    v_add_u32 v2, s20, v2
    s_lshl_b32 s21, s60, 1
    v_mov_b32 v3, s21
    s_waitcnt lgkmcnt(0)
    global_load_ushort v26, v3, s[16:17]
    global_load_ushort v8, v2, s[4:5] offset:0
    global_load_ushort v9, v2, s[6:7] offset:0
    global_load_ushort v10, v2, s[8:9] offset:0
    global_load_ushort v11, v2, s[10:11] offset:0
    global_load_ushort v12, v2, s[12:13] offset:0
    global_load_ushort v13, v2, s[14:15] offset:0
    global_load_ushort v14, v2, s[4:5] offset:128
    global_load_ushort v15, v2, s[6:7] offset:128
    global_load_ushort v16, v2, s[8:9] offset:128
    global_load_ushort v17, v2, s[10:11] offset:128
    global_load_ushort v18, v2, s[12:13] offset:128
    global_load_ushort v19, v2, s[14:15] offset:128
    global_load_ushort v20, v2, s[4:5] offset:256
    global_load_ushort v21, v2, s[6:7] offset:256
    global_load_ushort v22, v2, s[8:9] offset:256
    global_load_ushort v23, v2, s[10:11] offset:256
    global_load_ushort v24, v2, s[12:13] offset:256
    global_load_ushort v25, v2, s[14:15] offset:256
c_nopar:
    s_branch k_c
k_g:
    s_sub_u32 s3, s2, 256
    s_setprio 2
    s_and_b32 s20, s3, 7
    s_lshr_b32 s21, s3, 3
    s_lshr_b32 s22, s20, 1
    s_lshl_b32 s22, s22, 2
    s_and_b32 s23, s21, 3
    s_add_u32 s60, s22, s23
    s_and_b32 s22, s20, 1
    s_lshl_b32 s22, s22, 3
    s_lshr_b32 s23, s21, 2
    s_add_u32 s61, s22, s23
    s_load_dwordx2 s[4:5], s[0:1], 120
    s_load_dwordx2 s[6:7], s[0:1], 80
    s_load_dwordx2 s[8:9], s[0:1], 88
    s_load_dwordx2 s[10:11], s[0:1], 0
    s_load_dwordx2 s[12:13], s[0:1], 96
    s_load_dwordx2 s[14:15], s[0:1], 104
    s_load_dwordx2 s[16:17], s[0:1], 64
    v_lshrrev_b32 v12, 6, v0
    v_and_b32 v1, 63, v0
    v_readfirstlane_b32 s62, v12
    s_waitcnt lgkmcnt(0)
    s_mov_b32 s24, s10
    s_mov_b32 s25, s11
    s_mov_b32 s26, 2621440
    s_mov_b32 s27, 0x00020000
    s_cmp_ge_u32 s62, 2
    s_cselect_b32 s28, s8, s6
    s_cselect_b32 s29, s9, s7
    s_mov_b32 s30, 1966080
    s_mov_b32 s31, 0x00020000
    v_lshrrev_b32 v13, 3, v1
    v_lshrrev_b32 v14, 4, v1
    v_and_b32 v15, 7, v1
    v_xor_b32 v16, v15, v14
    v_xor_b32 v17, 4, v16
    s_lshl_b32 s20, s60, 7
    s_lshl_b32 s21, s62, 5
    s_add_u32 s20, s20, s21
    v_add_u32 v13, s20, v13
    v_mul_u32_u24 v13, 1280, v13
    v_lshl_add_u32 v2, v16, 4, v13
    v_lshl_add_u32 v11, v17, 4, v13
    v_add_u32 v11, 10240, v11
    s_lshl_b32 s40, s62, 12
    s_add_u32 s40, s40, 49152
    s_lshr_b32 s20, s3, 3
    s_and_b32 s21, s20, 3
    s_mul_i32 s21, s21, 3
    s_lshr_b32 s20, s20, 2
    s_add_u32 s20, s20, s21
    s_cmp_ge_u32 s20, 10
    s_cselect_b32 s21, 10, 0
    s_sub_u32 s63, s20, s21
    s_mov_b32 s64, 1966080
    s_mov_b32 s65, 1280
    s_mov_b32 s66, 1280
    s_add_u32 s20, s63, 0
    s_cmp_ge_u32 s20, 10
    s_cselect_b32 s21, 10, 0
    s_sub_u32 s20, s20, s21
    s_lshl_b32 s45, s20, 7
    s_add_u32 s35, s45, 20480
    s_add_u32 m0, s40, 0
    s_nop 0
    buffer_load_dwordx4 v2, s[24:27], s45 offen lds
    s_add_u32 m0, s40, 1024
    s_nop 0
    buffer_load_dwordx4 v11, s[24:27], s45 offen lds
    s_add_u32 m0, s40, 2048
    s_nop 0
    buffer_load_dwordx4 v2, s[24:27], s35 offen lds
    s_add_u32 m0, s40, 3072
    s_nop 0
    buffer_load_dwordx4 v11, s[24:27], s35 offen lds
    s_and_b32 s21, s62, 1
    s_mul_i32 s21, s21, 192
    s_lshr_b32 s22, s62, 1
    s_lshl_b32 s22, s22, 1
    s_mul_i32 s23, s61, 192
    s_mov_b32 s33, 0x15555556
    v_add_u32 v13, s21, v1
    v_mul_hi_u32 v14, v13, s33
    v_mul_u32_u24 v15, 12, v14
    v_sub_u32 v15, v13, v15
    v_xor_b32 v15, s22, v15
    v_mul_u32_u24 v14, 3072, v14
    v_lshl_add_u32 v14, v15, 4, v14
    v_add_u32 v3, s23, v14
    v_add_u32 v13, s21, v1
    v_add_u32 v13, 64, v13
    v_mul_hi_u32 v14, v13, s33
    v_mul_u32_u24 v15, 12, v14
    v_sub_u32 v15, v13, v15
    v_xor_b32 v15, s22, v15
    v_mul_u32_u24 v14, 3072, v14
    v_lshl_add_u32 v14, v15, 4, v14
    v_add_u32 v4, s23, v14
    v_add_u32 v13, s21, v1
    v_add_u32 v13, 128, v13
    v_mul_hi_u32 v14, v13, s33
    v_mul_u32_u24 v15, 12, v14
    v_sub_u32 v15, v13, v15
    v_xor_b32 v15, s22, v15
    v_mul_u32_u24 v14, 3072, v14
    v_lshl_add_u32 v14, v15, 4, v14
    v_add_u32 v5, s23, v14
    s_lshr_b32 s41, s62, 1
    s_mul_i32 s41, s41, 6144
    s_and_b32 s42, s62, 1
    s_mul_i32 s42, s42, 3072
    s_add_u32 s41, s41, s42
    s_lshl_b32 s20, s63, 1
    s_add_u32 s20, s20, 0
    s_cmp_ge_u32 s20, 20
    s_cselect_b32 s21, 20, 0
    s_sub_u32 s20, s20, s21
    s_mul_i32 s46, s20, 98304
    s_add_u32 m0, s41, 0
    s_nop 0
    buffer_load_dwordx4 v3, s[28:31], s46 offen lds
    s_add_u32 m0, s41, 1024
    s_nop 0
    buffer_load_dwordx4 v4, s[28:31], s46 offen lds
    s_add_u32 m0, s41, 2048
    s_nop 0
    buffer_load_dwordx4 v5, s[28:31], s46 offen lds
    s_lshl_b32 s20, s63, 1
    s_add_u32 s20, s20, 1
    s_cmp_ge_u32 s20, 20
    s_cselect_b32 s21, 20, 0
    s_sub_u32 s20, s20, s21
    s_mul_i32 s46, s20, 98304
    s_add_u32 m0, s41, 12288
    s_nop 0
    buffer_load_dwordx4 v3, s[28:31], s46 offen lds
    s_add_u32 m0, s41, 13312
    s_nop 0
    buffer_load_dwordx4 v4, s[28:31], s46 offen lds
    s_add_u32 m0, s41, 14336
    s_nop 0
    buffer_load_dwordx4 v5, s[28:31], s46 offen lds
    s_lshl_b32 s20, s63, 1
    s_add_u32 s20, s20, 2
    s_cmp_ge_u32 s20, 20
    s_cselect_b32 s21, 20, 0
    s_sub_u32 s20, s20, s21
    s_mul_i32 s46, s20, 98304
    s_add_u32 m0, s41, 24576
    s_nop 0
    buffer_load_dwordx4 v3, s[28:31], s46 offen lds
    s_add_u32 m0, s41, 25600
    s_nop 0
    buffer_load_dwordx4 v4, s[28:31], s46 offen lds
    s_add_u32 m0, s41, 26624
    s_nop 0
    buffer_load_dwordx4 v5, s[28:31], s46 offen lds
    s_add_u32 s20, s63, 1
    s_cmp_ge_u32 s20, 10
    s_cselect_b32 s21, 10, 0
    s_sub_u32 s20, s20, s21
    s_lshl_b32 s45, s20, 7
    s_add_u32 s35, s45, 20480
    s_add_u32 m0, s40, 16384
    s_nop 0
    buffer_load_dwordx4 v2, s[24:27], s45 offen lds
    s_add_u32 m0, s40, 17408
    s_nop 0
    buffer_load_dwordx4 v11, s[24:27], s45 offen lds
    s_lshl_b32 s20, s63, 1
    s_add_u32 s20, s20, 3
    s_cmp_ge_u32 s20, 20
    s_cselect_b32 s21, 20, 0
    s_sub_u32 s20, s20, s21
    s_mul_i32 s46, s20, 98304
    s_mov_b32 s34, s35
    s_add_u32 s20, s63, 2
    s_cmp_ge_u32 s20, 10
    s_cselect_b32 s21, 10, 0
    s_sub_u32 s20, s20, s21
    s_lshl_b32 s45, s20, 7
    s_add_u32 s35, s45, 20480
    s_mov_b32 s35, s34
    s_add_u32 s36, s4, 7864320
    s_addc_u32 s37, s5, 0
    s_mov_b32 s38, 6291456
    s_mov_b32 s39, 0x00020000
    s_add_u32 s48, s4, 14155776
    s_addc_u32 s49, s5, 0
    s_mov_b32 s50, 32768
    s_mov_b32 s51, 0x00020000
    s_add_u32 s72, s4, 14680064
    s_addc_u32 s73, s5, 0
    s_mov_b32 s74, 212992
    s_mov_b32 s75, 0x00020000
    s_lshr_b32 s43, s62, 1
    s_and_b32 s44, s62, 1
    v_and_b32 v13, 31, v1
    v_lshrrev_b32 v14, 5, v1
    v_bfe_u32 v15, v13, 1, 3
    v_xor_b32 v15, v15, v14
    v_lshlrev_b32 v13, 7, v13
    s_lshl_b32 s20, s43, 13
    s_add_u32 s20, s20, 49152
    v_add_u32 v13, s20, v13
    v_lshl_add_u32 v6, v15, 4, v13
    v_xor_b32 v7, 32, v6
    v_xor_b32 v27, 64, v6
    v_xor_b32 v28, 96, v6
    v_bfe_u32 v13, v1, 4, 1
    v_bfe_u32 v15, v1, 2, 2
    v_lshl_add_u32 v15, v14, 3, v15
    v_mul_u32_u24 v15, 192, v15
    v_mul_u32_u24 v16, 6144, v13
    v_add_u32 v15, v15, v16
    v_and_b32 v16, 3, v1
    v_lshl_add_u32 v15, v16, 3, v15
    s_mul_i32 s20, s44, 3
    s_add_u32 s21, s20, 0
    v_xor_b32 v16, s21, v13
    v_lshl_add_u32 v8, v16, 5, v15
    s_add_u32 s21, s20, 1
    v_xor_b32 v16, s21, v13
    v_lshl_add_u32 v9, v16, 5, v15
    s_add_u32 s21, s20, 2
    v_xor_b32 v16, s21, v13
    v_lshl_add_u32 v10, v16, 5, v15
    v_and_b32 v13, 15, v1
    v_bfe_u32 v14, v1, 4, 1
    v_cmp_eq_u32 vcc, v13, v14
    v_mov_b32 v13, 0x3f803f80
    s_nop 0
    v_cndmask_b32 v16, 0, v13, vcc
    v_cndmask_b32 v17, 0, v13, vcc
    v_cndmask_b32 v18, 0, v13, vcc
    v_cndmask_b32 v19, 0, v13, vcc
    v_mov_b32 v64, 0
    v_mov_b32 v65, 0
    v_mov_b32 v66, 0
    v_mov_b32 v67, 0
    v_mov_b32 v68, 0
    v_mov_b32 v69, 0
    v_mov_b32 v70, 0
    v_mov_b32 v71, 0
    v_mov_b32 v72, 0
    v_mov_b32 v73, 0
    v_mov_b32 v74, 0
    v_mov_b32 v75, 0
    v_mov_b32 v76, 0
    v_mov_b32 v77, 0
    v_mov_b32 v78, 0
    v_mov_b32 v79, 0
    v_mov_b32 v80, 0
    v_mov_b32 v81, 0
    v_mov_b32 v82, 0
    v_mov_b32 v83, 0
    v_mov_b32 v84, 0
    v_mov_b32 v85, 0
    v_mov_b32 v86, 0
    v_mov_b32 v87, 0
    v_mov_b32 v88, 0
    v_mov_b32 v89, 0
    v_mov_b32 v90, 0
    v_mov_b32 v91, 0
    v_mov_b32 v92, 0
    v_mov_b32 v93, 0
    v_mov_b32 v94, 0
    v_mov_b32 v95, 0
    v_mov_b32 v96, 0
    v_mov_b32 v97, 0
    v_mov_b32 v98, 0
    v_mov_b32 v99, 0
    v_mov_b32 v100, 0
    v_mov_b32 v101, 0
    v_mov_b32 v102, 0
    v_mov_b32 v103, 0
    v_mov_b32 v104, 0
    v_mov_b32 v105, 0
    v_mov_b32 v106, 0
    v_mov_b32 v107, 0
    v_mov_b32 v108, 0
    v_mov_b32 v109, 0
    v_mov_b32 v110, 0
    v_mov_b32 v111, 0
    v_mov_b32 v112, 0
    v_mov_b32 v113, 0
    v_mov_b32 v114, 0
    v_mov_b32 v115, 0
    v_mov_b32 v116, 0
    v_mov_b32 v117, 0
    v_mov_b32 v118, 0
    v_mov_b32 v119, 0
    v_mov_b32 v120, 0
    v_mov_b32 v121, 0
    v_mov_b32 v122, 0
    v_mov_b32 v123, 0
    v_mov_b32 v124, 0
    v_mov_b32 v125, 0
    v_mov_b32 v126, 0
    v_mov_b32 v127, 0
    v_mov_b32 v128, 0
    v_mov_b32 v129, 0
    v_mov_b32 v130, 0
    v_mov_b32 v131, 0
    v_mov_b32 v132, 0
    v_mov_b32 v133, 0
    v_mov_b32 v134, 0
    v_mov_b32 v135, 0
    v_mov_b32 v136, 0
    v_mov_b32 v137, 0
    v_mov_b32 v138, 0
    v_mov_b32 v139, 0
    v_mov_b32 v140, 0
    v_mov_b32 v141, 0
    v_mov_b32 v142, 0
    v_mov_b32 v143, 0
    v_mov_b32 v144, 0
    v_mov_b32 v145, 0
    v_mov_b32 v146, 0
    v_mov_b32 v147, 0
    v_mov_b32 v148, 0
    v_mov_b32 v149, 0
    v_mov_b32 v150, 0
    v_mov_b32 v151, 0
    v_mov_b32 v152, 0
    v_mov_b32 v153, 0
    v_mov_b32 v154, 0
    v_mov_b32 v155, 0
    v_mov_b32 v156, 0
    v_mov_b32 v157, 0
    v_mov_b32 v158, 0
    v_mov_b32 v159, 0
    v_mov_b32 v200, 0
    v_mov_b32 v201, 0
    v_mov_b32 v202, 0
    v_mov_b32 v203, 0
    v_mov_b32 v204, 0
    v_mov_b32 v205, 0
    v_mov_b32 v206, 0
    v_mov_b32 v207, 0
    v_mov_b32 v208, 0
    v_mov_b32 v209, 0
    v_mov_b32 v210, 0
    v_mov_b32 v211, 0
    s_load_dwordx2 s[18:19], s[0:1], 112
    v_mov_b32 v21, 0
    v_and_b32 v23, 31, v1
    s_lshl_b32 s20, s60, 7
    s_lshl_b32 s21, s43, 6
    s_add_u32 s20, s20, s21
    v_add_u32 v23, s20, v23
    v_and_b32 v22, 7, v23
    v_lshrrev_b32 v23, 3, v23
    v_lshlrev_b32 v23, 7, v23
    v_lshl_add_u32 v23, v22, 3, v23
    s_mov_b32 s33, 4096
    s_waitcnt lgkmcnt(0)
    s_cmp_eq_u32 s43, 0
    s_cbranch_scc0 g_m1
    s_waitcnt vmcnt(8)
    s_barrier
    ds_read_b128 v[160:163], v6 offset:0
    ds_read_b64_tr_b16 v[168:169], v8 offset:0
    ds_read_b64_tr_b16 v[170:171], v8 offset:768
    ds_read_b128 v[164:167], v6 offset:4096
    ds_read_b64_tr_b16 v[172:173], v9 offset:0
    ds_read_b64_tr_b16 v[174:175], v9 offset:768
    ds_read_b64_tr_b16 v[176:177], v10 offset:0
    ds_read_b64_tr_b16 v[178:179], v10 offset:768
    s_mov_b32 s47, 4
g_m0l_loop:
    s_waitcnt lgkmcnt(0)
    v_mfma_f32_32x32x16_bf16 v[64:79], v[168:171], v[160:163], v[64:79]
    ds_read_b128 v[180:183], v7 offset:0
    s_add_u32 m0, s40, 18432
    ds_read_b64_tr_b16 v[188:189], v8 offset:3072
    buffer_load_dwordx4 v2, s[24:27], s35 offen lds
    v_mfma_f32_32x32x16_bf16 v[80:95], v[168:171], v[164:167], v[80:95]
    v_mfma_f32_16x16x32_bf16 v[200:203], v[168:171], v[16:19], v[200:203]
    ds_read_b64_tr_b16 v[190:191], v8 offset:3840
    ds_read_b128 v[184:187], v7 offset:4096
    v_mfma_f32_32x32x16_bf16 v[96:111], v[172:175], v[160:163], v[96:111]
    ds_read_b64_tr_b16 v[192:193], v9 offset:3072
    s_add_u32 m0, s41, 36864
    ds_read_b64_tr_b16 v[194:195], v9 offset:3840
    buffer_load_dwordx4 v3, s[28:31], s46 offen lds
    v_mfma_f32_32x32x16_bf16 v[112:127], v[172:175], v[164:167], v[112:127]
    v_mfma_f32_16x16x32_bf16 v[204:207], v[172:175], v[16:19], v[204:207]
    ds_read_b64_tr_b16 v[196:197], v10 offset:3072
    ds_read_b64_tr_b16 v[198:199], v10 offset:3840
    v_mfma_f32_32x32x16_bf16 v[128:143], v[176:179], v[160:163], v[128:143]
    s_add_u32 m0, s40, 19456
    s_nop 0
    buffer_load_dwordx4 v11, s[24:27], s35 offen lds
    v_mfma_f32_32x32x16_bf16 v[144:159], v[176:179], v[164:167], v[144:159]
    v_mfma_f32_16x16x32_bf16 v[208:211], v[176:179], v[16:19], v[208:211]
    s_add_u32 s35, s35, 128
    s_cmp_ge_u32 s35, 21760
    s_cselect_b32 s21, s65, 0
    s_sub_u32 s35, s35, s21
    s_waitcnt vmcnt(8) lgkmcnt(0)
    s_barrier
    v_mfma_f32_32x32x16_bf16 v[64:79], v[188:191], v[180:183], v[64:79]
    ds_read_b128 v[160:163], v27 offset:0
    ds_read_b64_tr_b16 v[168:169], v8 offset:12288
    v_mfma_f32_32x32x16_bf16 v[80:95], v[188:191], v[184:187], v[80:95]
    ds_read_b64_tr_b16 v[170:171], v8 offset:13056
    s_add_u32 m0, s41, 37888
    ds_read_b128 v[164:167], v27 offset:4096
    buffer_load_dwordx4 v4, s[28:31], s46 offen lds
    v_mfma_f32_32x32x16_bf16 v[96:111], v[192:195], v[180:183], v[96:111]
    ds_read_b64_tr_b16 v[172:173], v9 offset:12288
    ds_read_b64_tr_b16 v[174:175], v9 offset:13056
    v_mfma_f32_32x32x16_bf16 v[112:127], v[192:195], v[184:187], v[112:127]
    ds_read_b64_tr_b16 v[176:177], v10 offset:12288
    ds_read_b64_tr_b16 v[178:179], v10 offset:13056
    v_mfma_f32_32x32x16_bf16 v[128:143], v[196:199], v[180:183], v[128:143]
    s_add_u32 m0, s41, 38912
    s_nop 0
    buffer_load_dwordx4 v5, s[28:31], s46 offen lds
    v_mfma_f32_32x32x16_bf16 v[144:159], v[196:199], v[184:187], v[144:159]
    s_add_u32 s46, s46, 98304
    s_cmp_ge_u32 s46, 1966080
    s_cselect_b32 s21, s64, 0
    s_sub_u32 s46, s46, s21
    s_waitcnt lgkmcnt(0)
    v_mfma_f32_32x32x16_bf16 v[64:79], v[168:171], v[160:163], v[64:79]
    ds_read_b128 v[180:183], v28 offset:0
    s_add_u32 m0, s41, 0
    ds_read_b64_tr_b16 v[188:189], v8 offset:15360
    buffer_load_dwordx4 v3, s[28:31], s46 offen lds
    v_mfma_f32_32x32x16_bf16 v[80:95], v[168:171], v[164:167], v[80:95]
    v_mfma_f32_16x16x32_bf16 v[200:203], v[168:171], v[16:19], v[200:203]
    ds_read_b64_tr_b16 v[190:191], v8 offset:16128
    ds_read_b128 v[184:187], v28 offset:4096
    v_mfma_f32_32x32x16_bf16 v[96:111], v[172:175], v[160:163], v[96:111]
    ds_read_b64_tr_b16 v[192:193], v9 offset:15360
    s_add_u32 m0, s41, 1024
    ds_read_b64_tr_b16 v[194:195], v9 offset:16128
    buffer_load_dwordx4 v4, s[28:31], s46 offen lds
    v_mfma_f32_32x32x16_bf16 v[112:127], v[172:175], v[164:167], v[112:127]
    v_mfma_f32_16x16x32_bf16 v[204:207], v[172:175], v[16:19], v[204:207]
    ds_read_b64_tr_b16 v[196:197], v10 offset:15360
    ds_read_b64_tr_b16 v[198:199], v10 offset:16128
    v_mfma_f32_32x32x16_bf16 v[128:143], v[176:179], v[160:163], v[128:143]
    s_add_u32 m0, s41, 2048
    s_nop 0
    buffer_load_dwordx4 v5, s[28:31], s46 offen lds
    v_mfma_f32_32x32x16_bf16 v[144:159], v[176:179], v[164:167], v[144:159]
    v_mfma_f32_16x16x32_bf16 v[208:211], v[176:179], v[16:19], v[208:211]
    s_add_u32 s46, s46, 98304
    s_cmp_ge_u32 s46, 1966080
    s_cselect_b32 s21, s64, 0
    s_sub_u32 s46, s46, s21
    s_waitcnt vmcnt(5) lgkmcnt(0)
    s_barrier
    s_cmp_eq_u32 s47, 1
    s_cbranch_scc0 g_m0l_c1
g_m0l_chk:
    v_readfirstlane_b32 s70, v20
    v_xor_b32 v29, v20, v253
    v_xor_b32 v22, v20, v255
    v_or_b32 v29, v29, v22
    v_cmp_ne_u32 vcc, 0, v29
    s_cmp_eq_u32 s70, 0
    s_cbranch_scc1 g_m0l_slow
    s_nop 1
    s_cbranch_vccz g_m0l_fast
g_m0l_slow:
    s_sub_u32 s33, s33, 1
    s_cmp_eq_u32 s33, 0
    s_cbranch_scc1 g_m0l_fast
    s_sleep 4
    global_load_dword v20, v21, s[18:19] sc1
    buffer_load_dwordx2 v[252:253], v23, s[48:51], 0 offen sc1
    buffer_load_dwordx2 v[254:255], v23, s[48:51], 0 offen offset:512 sc1
    s_waitcnt vmcnt(0)
    s_branch g_m0l_chk
g_m0l_fast:
g_m0l_c1:
    v_mfma_f32_32x32x16_bf16 v[64:79], v[188:191], v[180:183], v[64:79]
    ds_read_b128 v[160:163], v6 offset:16384
    ds_read_b64_tr_b16 v[168:169], v8 offset:24576
    v_mfma_f32_32x32x16_bf16 v[80:95], v[188:191], v[184:187], v[80:95]
    ds_read_b64_tr_b16 v[170:171], v8 offset:25344
    s_add_u32 m0, s40, 0
    ds_read_b128 v[164:167], v6 offset:20480
    buffer_load_dwordx4 v2, s[24:27], s45 offen lds
    v_mfma_f32_32x32x16_bf16 v[96:111], v[192:195], v[180:183], v[96:111]
    ds_read_b64_tr_b16 v[172:173], v9 offset:24576
    ds_read_b64_tr_b16 v[174:175], v9 offset:25344
    v_mfma_f32_32x32x16_bf16 v[112:127], v[192:195], v[184:187], v[112:127]
    ds_read_b64_tr_b16 v[176:177], v10 offset:24576
    ds_read_b64_tr_b16 v[178:179], v10 offset:25344
    v_mfma_f32_32x32x16_bf16 v[128:143], v[196:199], v[180:183], v[128:143]
    s_add_u32 m0, s40, 1024
    s_nop 0
    buffer_load_dwordx4 v11, s[24:27], s45 offen lds
    v_mfma_f32_32x32x16_bf16 v[144:159], v[196:199], v[184:187], v[144:159]
    s_add_u32 s45, s45, 128
    s_cmp_ge_u32 s45, 1280
    s_cselect_b32 s21, s65, 0
    s_sub_u32 s45, s45, s21
    s_waitcnt lgkmcnt(0)
    v_mfma_f32_32x32x16_bf16 v[64:79], v[168:171], v[160:163], v[64:79]
    ds_read_b128 v[180:183], v7 offset:16384
    s_add_u32 m0, s40, 2048
    ds_read_b64_tr_b16 v[188:189], v8 offset:27648
    buffer_load_dwordx4 v2, s[24:27], s35 offen lds
    v_mfma_f32_32x32x16_bf16 v[80:95], v[168:171], v[164:167], v[80:95]
    v_mfma_f32_16x16x32_bf16 v[200:203], v[168:171], v[16:19], v[200:203]
    ds_read_b64_tr_b16 v[190:191], v8 offset:28416
    ds_read_b128 v[184:187], v7 offset:20480
    v_mfma_f32_32x32x16_bf16 v[96:111], v[172:175], v[160:163], v[96:111]
    ds_read_b64_tr_b16 v[192:193], v9 offset:27648
    s_add_u32 m0, s41, 12288
    ds_read_b64_tr_b16 v[194:195], v9 offset:28416
    buffer_load_dwordx4 v3, s[28:31], s46 offen lds
    v_mfma_f32_32x32x16_bf16 v[112:127], v[172:175], v[164:167], v[112:127]
    v_mfma_f32_16x16x32_bf16 v[204:207], v[172:175], v[16:19], v[204:207]
    ds_read_b64_tr_b16 v[196:197], v10 offset:27648
    ds_read_b64_tr_b16 v[198:199], v10 offset:28416
    v_mfma_f32_32x32x16_bf16 v[128:143], v[176:179], v[160:163], v[128:143]
    s_add_u32 m0, s40, 3072
    s_nop 0
    buffer_load_dwordx4 v11, s[24:27], s35 offen lds
    v_mfma_f32_32x32x16_bf16 v[144:159], v[176:179], v[164:167], v[144:159]
    v_mfma_f32_16x16x32_bf16 v[208:211], v[176:179], v[16:19], v[208:211]
    s_add_u32 s35, s35, 128
    s_cmp_ge_u32 s35, 21760
    s_cselect_b32 s21, s65, 0
    s_sub_u32 s35, s35, s21
    s_waitcnt vmcnt(8) lgkmcnt(0)
    s_barrier
    v_mfma_f32_32x32x16_bf16 v[64:79], v[188:191], v[180:183], v[64:79]
    ds_read_b128 v[160:163], v27 offset:16384
    ds_read_b64_tr_b16 v[168:169], v8 offset:36864
    v_mfma_f32_32x32x16_bf16 v[80:95], v[188:191], v[184:187], v[80:95]
    ds_read_b64_tr_b16 v[170:171], v8 offset:37632
    s_add_u32 m0, s41, 13312
    ds_read_b128 v[164:167], v27 offset:20480
    buffer_load_dwordx4 v4, s[28:31], s46 offen lds
    v_mfma_f32_32x32x16_bf16 v[96:111], v[192:195], v[180:183], v[96:111]
    ds_read_b64_tr_b16 v[172:173], v9 offset:36864
    ds_read_b64_tr_b16 v[174:175], v9 offset:37632
    v_mfma_f32_32x32x16_bf16 v[112:127], v[192:195], v[184:187], v[112:127]
    ds_read_b64_tr_b16 v[176:177], v10 offset:36864
    ds_read_b64_tr_b16 v[178:179], v10 offset:37632
    v_mfma_f32_32x32x16_bf16 v[128:143], v[196:199], v[180:183], v[128:143]
    s_add_u32 m0, s41, 14336
    s_nop 0
    buffer_load_dwordx4 v5, s[28:31], s46 offen lds
    v_mfma_f32_32x32x16_bf16 v[144:159], v[196:199], v[184:187], v[144:159]
    s_add_u32 s46, s46, 98304
    s_cmp_ge_u32 s46, 1966080
    s_cselect_b32 s21, s64, 0
    s_sub_u32 s46, s46, s21
    s_waitcnt lgkmcnt(0)
    v_mfma_f32_32x32x16_bf16 v[64:79], v[168:171], v[160:163], v[64:79]
    ds_read_b128 v[180:183], v28 offset:16384
    s_add_u32 m0, s41, 24576
    ds_read_b64_tr_b16 v[188:189], v8 offset:39936
    buffer_load_dwordx4 v3, s[28:31], s46 offen lds
    v_mfma_f32_32x32x16_bf16 v[80:95], v[168:171], v[164:167], v[80:95]
    v_mfma_f32_16x16x32_bf16 v[200:203], v[168:171], v[16:19], v[200:203]
    ds_read_b64_tr_b16 v[190:191], v8 offset:40704
    ds_read_b128 v[184:187], v28 offset:20480
    v_mfma_f32_32x32x16_bf16 v[96:111], v[172:175], v[160:163], v[96:111]
    ds_read_b64_tr_b16 v[192:193], v9 offset:39936
    s_add_u32 m0, s41, 25600
    ds_read_b64_tr_b16 v[194:195], v9 offset:40704
    buffer_load_dwordx4 v4, s[28:31], s46 offen lds
    v_mfma_f32_32x32x16_bf16 v[112:127], v[172:175], v[164:167], v[112:127]
    v_mfma_f32_16x16x32_bf16 v[204:207], v[172:175], v[16:19], v[204:207]
    ds_read_b64_tr_b16 v[196:197], v10 offset:39936
    ds_read_b64_tr_b16 v[198:199], v10 offset:40704
    v_mfma_f32_32x32x16_bf16 v[128:143], v[176:179], v[160:163], v[128:143]
    s_add_u32 m0, s41, 26624
    s_nop 0
    buffer_load_dwordx4 v5, s[28:31], s46 offen lds
    v_mfma_f32_32x32x16_bf16 v[144:159], v[176:179], v[164:167], v[144:159]
    v_mfma_f32_16x16x32_bf16 v[208:211], v[176:179], v[16:19], v[208:211]
    s_add_u32 s46, s46, 98304
    s_cmp_ge_u32 s46, 1966080
    s_cselect_b32 s21, s64, 0
    s_sub_u32 s46, s46, s21
    s_waitcnt vmcnt(5) lgkmcnt(0)
    s_barrier
    v_mfma_f32_32x32x16_bf16 v[64:79], v[188:191], v[180:183], v[64:79]
    ds_read_b128 v[160:163], v6 offset:0
    ds_read_b64_tr_b16 v[168:169], v8 offset:0
    v_mfma_f32_32x32x16_bf16 v[80:95], v[188:191], v[184:187], v[80:95]
    ds_read_b64_tr_b16 v[170:171], v8 offset:768
    s_add_u32 m0, s40, 16384
    ds_read_b128 v[164:167], v6 offset:4096
    buffer_load_dwordx4 v2, s[24:27], s45 offen lds
    v_mfma_f32_32x32x16_bf16 v[96:111], v[192:195], v[180:183], v[96:111]
    ds_read_b64_tr_b16 v[172:173], v9 offset:0
    ds_read_b64_tr_b16 v[174:175], v9 offset:768
    v_mfma_f32_32x32x16_bf16 v[112:127], v[192:195], v[184:187], v[112:127]
    ds_read_b64_tr_b16 v[176:177], v10 offset:0
    ds_read_b64_tr_b16 v[178:179], v10 offset:768
    v_mfma_f32_32x32x16_bf16 v[128:143], v[196:199], v[180:183], v[128:143]
    s_add_u32 m0, s40, 17408
    s_nop 0
    buffer_load_dwordx4 v11, s[24:27], s45 offen lds
    v_mfma_f32_32x32x16_bf16 v[144:159], v[196:199], v[184:187], v[144:159]
    s_add_u32 s45, s45, 128
    s_cmp_ge_u32 s45, 1280
    s_cselect_b32 s21, s65, 0
    s_sub_u32 s45, s45, s21
    s_cmp_eq_u32 s47, 2
    s_cbranch_scc0 g_m0l_c2
    global_load_dword v20, v21, s[18:19] sc1
    buffer_load_dwordx2 v[252:253], v23, s[48:51], 0 offen sc1
    buffer_load_dwordx2 v[254:255], v23, s[48:51], 0 offen offset:512 sc1
g_m0l_c2:
    s_sub_u32 s47, s47, 1
    s_cmp_lg_u32 s47, 0
    s_cbranch_scc1 g_m0l_loop
    s_waitcnt lgkmcnt(0)
    v_mfma_f32_32x32x16_bf16 v[64:79], v[168:171], v[160:163], v[64:79]
    ds_read_b128 v[180:183], v7 offset:0
    s_add_u32 m0, s40, 18432
    ds_read_b64_tr_b16 v[188:189], v8 offset:3072
    buffer_load_dwordx4 v2, s[24:27], s35 offen lds
    v_mfma_f32_32x32x16_bf16 v[80:95], v[168:171], v[164:167], v[80:95]
    v_mfma_f32_16x16x32_bf16 v[200:203], v[168:171], v[16:19], v[200:203]
    ds_read_b64_tr_b16 v[190:191], v8 offset:3840
    ds_read_b128 v[184:187], v7 offset:4096
    v_mfma_f32_32x32x16_bf16 v[96:111], v[172:175], v[160:163], v[96:111]
    ds_read_b64_tr_b16 v[192:193], v9 offset:3072
    s_add_u32 m0, s41, 36864
    ds_read_b64_tr_b16 v[194:195], v9 offset:3840
    buffer_load_dwordx4 v3, s[28:31], s46 offen lds
    v_mfma_f32_32x32x16_bf16 v[112:127], v[172:175], v[164:167], v[112:127]
    v_mfma_f32_16x16x32_bf16 v[204:207], v[172:175], v[16:19], v[204:207]
    ds_read_b64_tr_b16 v[196:197], v10 offset:3072
    ds_read_b64_tr_b16 v[198:199], v10 offset:3840
    v_mfma_f32_32x32x16_bf16 v[128:143], v[176:179], v[160:163], v[128:143]
    s_add_u32 m0, s40, 19456
    s_nop 0
    buffer_load_dwordx4 v11, s[24:27], s35 offen lds
    v_mfma_f32_32x32x16_bf16 v[144:159], v[176:179], v[164:167], v[144:159]
    v_mfma_f32_16x16x32_bf16 v[208:211], v[176:179], v[16:19], v[208:211]
    s_add_u32 s35, s35, 128
    s_cmp_ge_u32 s35, 21760
    s_cselect_b32 s21, s65, 0
    s_sub_u32 s35, s35, s21
    s_waitcnt vmcnt(8) lgkmcnt(0)
    s_barrier
    v_mfma_f32_32x32x16_bf16 v[64:79], v[188:191], v[180:183], v[64:79]
    ds_read_b128 v[160:163], v27 offset:0
    ds_read_b64_tr_b16 v[168:169], v8 offset:12288
    v_mfma_f32_32x32x16_bf16 v[80:95], v[188:191], v[184:187], v[80:95]
    ds_read_b64_tr_b16 v[170:171], v8 offset:13056
    s_add_u32 m0, s41, 37888
    ds_read_b128 v[164:167], v27 offset:4096
    buffer_load_dwordx4 v4, s[28:31], s46 offen lds
    v_mfma_f32_32x32x16_bf16 v[96:111], v[192:195], v[180:183], v[96:111]
    ds_read_b64_tr_b16 v[172:173], v9 offset:12288
    ds_read_b64_tr_b16 v[174:175], v9 offset:13056
    v_mfma_f32_32x32x16_bf16 v[112:127], v[192:195], v[184:187], v[112:127]
    ds_read_b64_tr_b16 v[176:177], v10 offset:12288
    ds_read_b64_tr_b16 v[178:179], v10 offset:13056
    v_mfma_f32_32x32x16_bf16 v[128:143], v[196:199], v[180:183], v[128:143]
    s_add_u32 m0, s41, 38912
    s_nop 0
    buffer_load_dwordx4 v5, s[28:31], s46 offen lds
    v_mfma_f32_32x32x16_bf16 v[144:159], v[196:199], v[184:187], v[144:159]
    s_add_u32 s46, s46, 98304
    s_cmp_ge_u32 s46, 1966080
    s_cselect_b32 s21, s64, 0
    s_sub_u32 s46, s46, s21
    s_waitcnt lgkmcnt(0)
    v_mfma_f32_32x32x16_bf16 v[64:79], v[168:171], v[160:163], v[64:79]
    ds_read_b128 v[180:183], v28 offset:0
    ds_read_b64_tr_b16 v[188:189], v8 offset:15360
    v_mfma_f32_32x32x16_bf16 v[80:95], v[168:171], v[164:167], v[80:95]
    v_mfma_f32_16x16x32_bf16 v[200:203], v[168:171], v[16:19], v[200:203]
    ds_read_b64_tr_b16 v[190:191], v8 offset:16128
    ds_read_b128 v[184:187], v28 offset:4096
    v_mfma_f32_32x32x16_bf16 v[96:111], v[172:175], v[160:163], v[96:111]
    ds_read_b64_tr_b16 v[192:193], v9 offset:15360
    ds_read_b64_tr_b16 v[194:195], v9 offset:16128
    v_mfma_f32_32x32x16_bf16 v[112:127], v[172:175], v[164:167], v[112:127]
    v_mfma_f32_16x16x32_bf16 v[204:207], v[172:175], v[16:19], v[204:207]
    ds_read_b64_tr_b16 v[196:197], v10 offset:15360
    ds_read_b64_tr_b16 v[198:199], v10 offset:16128
    v_mfma_f32_32x32x16_bf16 v[128:143], v[176:179], v[160:163], v[128:143]
    v_mfma_f32_32x32x16_bf16 v[144:159], v[176:179], v[164:167], v[144:159]
    v_mfma_f32_16x16x32_bf16 v[208:211], v[176:179], v[16:19], v[208:211]
    s_waitcnt vmcnt(2) lgkmcnt(0)
    s_barrier
    v_mfma_f32_32x32x16_bf16 v[64:79], v[188:191], v[180:183], v[64:79]
    ds_read_b128 v[160:163], v6 offset:16384
    ds_read_b64_tr_b16 v[168:169], v8 offset:24576
    v_mfma_f32_32x32x16_bf16 v[80:95], v[188:191], v[184:187], v[80:95]
    ds_read_b64_tr_b16 v[170:171], v8 offset:25344
    ds_read_b128 v[164:167], v6 offset:20480
    v_mfma_f32_32x32x16_bf16 v[96:111], v[192:195], v[180:183], v[96:111]
    ds_read_b64_tr_b16 v[172:173], v9 offset:24576
    ds_read_b64_tr_b16 v[174:175], v9 offset:25344
    v_mfma_f32_32x32x16_bf16 v[112:127], v[192:195], v[184:187], v[112:127]
    ds_read_b64_tr_b16 v[176:177], v10 offset:24576
    ds_read_b64_tr_b16 v[178:179], v10 offset:25344
    v_mfma_f32_32x32x16_bf16 v[128:143], v[196:199], v[180:183], v[128:143]
    v_mfma_f32_32x32x16_bf16 v[144:159], v[196:199], v[184:187], v[144:159]
    s_waitcnt lgkmcnt(0)
    v_mfma_f32_32x32x16_bf16 v[64:79], v[168:171], v[160:163], v[64:79]
    ds_read_b128 v[180:183], v7 offset:16384
    ds_read_b64_tr_b16 v[188:189], v8 offset:27648
    v_mfma_f32_32x32x16_bf16 v[80:95], v[168:171], v[164:167], v[80:95]
    v_mfma_f32_16x16x32_bf16 v[200:203], v[168:171], v[16:19], v[200:203]
    ds_read_b64_tr_b16 v[190:191], v8 offset:28416
    ds_read_b128 v[184:187], v7 offset:20480
    v_mfma_f32_32x32x16_bf16 v[96:111], v[172:175], v[160:163], v[96:111]
    ds_read_b64_tr_b16 v[192:193], v9 offset:27648
    ds_read_b64_tr_b16 v[194:195], v9 offset:28416
    v_mfma_f32_32x32x16_bf16 v[112:127], v[172:175], v[164:167], v[112:127]
    v_mfma_f32_16x16x32_bf16 v[204:207], v[172:175], v[16:19], v[204:207]
    ds_read_b64_tr_b16 v[196:197], v10 offset:27648
    ds_read_b64_tr_b16 v[198:199], v10 offset:28416
    v_mfma_f32_32x32x16_bf16 v[128:143], v[176:179], v[160:163], v[128:143]
    v_mfma_f32_32x32x16_bf16 v[144:159], v[176:179], v[164:167], v[144:159]
    v_mfma_f32_16x16x32_bf16 v[208:211], v[176:179], v[16:19], v[208:211]
    s_waitcnt vmcnt(0) lgkmcnt(0)
    s_barrier
    v_mfma_f32_32x32x16_bf16 v[64:79], v[188:191], v[180:183], v[64:79]
    ds_read_b128 v[160:163], v27 offset:16384
    ds_read_b64_tr_b16 v[168:169], v8 offset:36864
    v_mfma_f32_32x32x16_bf16 v[80:95], v[188:191], v[184:187], v[80:95]
    ds_read_b64_tr_b16 v[170:171], v8 offset:37632
    ds_read_b128 v[164:167], v27 offset:20480
    v_mfma_f32_32x32x16_bf16 v[96:111], v[192:195], v[180:183], v[96:111]
    ds_read_b64_tr_b16 v[172:173], v9 offset:36864
    ds_read_b64_tr_b16 v[174:175], v9 offset:37632
    v_mfma_f32_32x32x16_bf16 v[112:127], v[192:195], v[184:187], v[112:127]
    ds_read_b64_tr_b16 v[176:177], v10 offset:36864
    ds_read_b64_tr_b16 v[178:179], v10 offset:37632
    v_mfma_f32_32x32x16_bf16 v[128:143], v[196:199], v[180:183], v[128:143]
    v_mfma_f32_32x32x16_bf16 v[144:159], v[196:199], v[184:187], v[144:159]
    s_waitcnt lgkmcnt(0)
    v_mfma_f32_32x32x16_bf16 v[64:79], v[168:171], v[160:163], v[64:79]
    ds_read_b128 v[180:183], v28 offset:16384
    ds_read_b64_tr_b16 v[188:189], v8 offset:39936
    v_mfma_f32_32x32x16_bf16 v[80:95], v[168:171], v[164:167], v[80:95]
    v_mfma_f32_16x16x32_bf16 v[200:203], v[168:171], v[16:19], v[200:203]
    ds_read_b64_tr_b16 v[190:191], v8 offset:40704
    ds_read_b128 v[184:187], v28 offset:20480
    v_mfma_f32_32x32x16_bf16 v[96:111], v[172:175], v[160:163], v[96:111]
    ds_read_b64_tr_b16 v[192:193], v9 offset:39936
    ds_read_b64_tr_b16 v[194:195], v9 offset:40704
    v_mfma_f32_32x32x16_bf16 v[112:127], v[172:175], v[164:167], v[112:127]
    v_mfma_f32_16x16x32_bf16 v[204:207], v[172:175], v[16:19], v[204:207]
    ds_read_b64_tr_b16 v[196:197], v10 offset:39936
    ds_read_b64_tr_b16 v[198:199], v10 offset:40704
    v_mfma_f32_32x32x16_bf16 v[128:143], v[176:179], v[160:163], v[128:143]
    v_mfma_f32_32x32x16_bf16 v[144:159], v[176:179], v[164:167], v[144:159]
    v_mfma_f32_16x16x32_bf16 v[208:211], v[176:179], v[16:19], v[208:211]
    s_waitcnt lgkmcnt(0)
    v_mfma_f32_32x32x16_bf16 v[64:79], v[188:191], v[180:183], v[64:79]
    v_mfma_f32_32x32x16_bf16 v[80:95], v[188:191], v[184:187], v[80:95]
    v_mfma_f32_32x32x16_bf16 v[96:111], v[192:195], v[180:183], v[96:111]
    v_mfma_f32_32x32x16_bf16 v[112:127], v[192:195], v[184:187], v[112:127]
    v_mfma_f32_32x32x16_bf16 v[128:143], v[196:199], v[180:183], v[128:143]
    v_mfma_f32_32x32x16_bf16 v[144:159], v[196:199], v[184:187], v[144:159]
    s_branch g_mdone
g_m1:
    s_waitcnt vmcnt(8)
    s_barrier
    ds_read_b128 v[160:163], v6 offset:0
    ds_read_b64_tr_b16 v[168:169], v8 offset:0
    ds_read_b64_tr_b16 v[170:171], v8 offset:768
    ds_read_b128 v[164:167], v6 offset:4096
    ds_read_b64_tr_b16 v[172:173], v9 offset:0
    ds_read_b64_tr_b16 v[174:175], v9 offset:768
    ds_read_b64_tr_b16 v[176:177], v10 offset:0
    ds_read_b64_tr_b16 v[178:179], v10 offset:768
    s_mov_b32 s47, 4
g_m1l_loop:
    s_waitcnt lgkmcnt(0)
    v_mfma_f32_32x32x16_bf16 v[64:79], v[168:171], v[160:163], v[64:79]
    ds_read_b128 v[180:183], v7 offset:0
    s_add_u32 m0, s40, 18432
    ds_read_b64_tr_b16 v[188:189], v8 offset:3072
    buffer_load_dwordx4 v2, s[24:27], s35 offen lds
    v_mfma_f32_32x32x16_bf16 v[80:95], v[168:171], v[164:167], v[80:95]
    ds_read_b64_tr_b16 v[190:191], v8 offset:3840
    ds_read_b128 v[184:187], v7 offset:4096
    v_mfma_f32_32x32x16_bf16 v[96:111], v[172:175], v[160:163], v[96:111]
    ds_read_b64_tr_b16 v[192:193], v9 offset:3072
    s_add_u32 m0, s41, 36864
    ds_read_b64_tr_b16 v[194:195], v9 offset:3840
    buffer_load_dwordx4 v3, s[28:31], s46 offen lds
    v_mfma_f32_32x32x16_bf16 v[112:127], v[172:175], v[164:167], v[112:127]
    ds_read_b64_tr_b16 v[196:197], v10 offset:3072
    ds_read_b64_tr_b16 v[198:199], v10 offset:3840
    v_mfma_f32_32x32x16_bf16 v[128:143], v[176:179], v[160:163], v[128:143]
    s_add_u32 m0, s40, 19456
    s_nop 0
    buffer_load_dwordx4 v11, s[24:27], s35 offen lds
    v_mfma_f32_32x32x16_bf16 v[144:159], v[176:179], v[164:167], v[144:159]
    s_add_u32 s35, s35, 128
    s_cmp_ge_u32 s35, 21760
    s_cselect_b32 s21, s65, 0
    s_sub_u32 s35, s35, s21
    s_waitcnt vmcnt(8) lgkmcnt(0)
    s_barrier
    v_mfma_f32_32x32x16_bf16 v[64:79], v[188:191], v[180:183], v[64:79]
    ds_read_b128 v[160:163], v27 offset:0
    ds_read_b64_tr_b16 v[168:169], v8 offset:12288
    v_mfma_f32_32x32x16_bf16 v[80:95], v[188:191], v[184:187], v[80:95]
    v_mfma_f32_16x16x32_bf16 v[200:203], v[188:191], v[16:19], v[200:203]
    ds_read_b64_tr_b16 v[170:171], v8 offset:13056
    s_add_u32 m0, s41, 37888
    ds_read_b128 v[164:167], v27 offset:4096
    buffer_load_dwordx4 v4, s[28:31], s46 offen lds
    v_mfma_f32_32x32x16_bf16 v[96:111], v[192:195], v[180:183], v[96:111]
    ds_read_b64_tr_b16 v[172:173], v9 offset:12288
    ds_read_b64_tr_b16 v[174:175], v9 offset:13056
    v_mfma_f32_32x32x16_bf16 v[112:127], v[192:195], v[184:187], v[112:127]
    v_mfma_f32_16x16x32_bf16 v[204:207], v[192:195], v[16:19], v[204:207]
    ds_read_b64_tr_b16 v[176:177], v10 offset:12288
    ds_read_b64_tr_b16 v[178:179], v10 offset:13056
    v_mfma_f32_32x32x16_bf16 v[128:143], v[196:199], v[180:183], v[128:143]
    s_add_u32 m0, s41, 38912
    s_nop 0
    buffer_load_dwordx4 v5, s[28:31], s46 offen lds
    v_mfma_f32_32x32x16_bf16 v[144:159], v[196:199], v[184:187], v[144:159]
    v_mfma_f32_16x16x32_bf16 v[208:211], v[196:199], v[16:19], v[208:211]
    s_add_u32 s46, s46, 98304
    s_cmp_ge_u32 s46, 1966080
    s_cselect_b32 s21, s64, 0
    s_sub_u32 s46, s46, s21
    s_waitcnt lgkmcnt(0)
    v_mfma_f32_32x32x16_bf16 v[64:79], v[168:171], v[160:163], v[64:79]
    ds_read_b128 v[180:183], v28 offset:0
    s_add_u32 m0, s41, 0
    ds_read_b64_tr_b16 v[188:189], v8 offset:15360
    buffer_load_dwordx4 v3, s[28:31], s46 offen lds
    v_mfma_f32_32x32x16_bf16 v[80:95], v[168:171], v[164:167], v[80:95]
    ds_read_b64_tr_b16 v[190:191], v8 offset:16128
    ds_read_b128 v[184:187], v28 offset:4096
    v_mfma_f32_32x32x16_bf16 v[96:111], v[172:175], v[160:163], v[96:111]
    ds_read_b64_tr_b16 v[192:193], v9 offset:15360
    s_add_u32 m0, s41, 1024
    ds_read_b64_tr_b16 v[194:195], v9 offset:16128
    buffer_load_dwordx4 v4, s[28:31], s46 offen lds
    v_mfma_f32_32x32x16_bf16 v[112:127], v[172:175], v[164:167], v[112:127]
    ds_read_b64_tr_b16 v[196:197], v10 offset:15360
    ds_read_b64_tr_b16 v[198:199], v10 offset:16128
    v_mfma_f32_32x32x16_bf16 v[128:143], v[176:179], v[160:163], v[128:143]
    s_add_u32 m0, s41, 2048
    s_nop 0
    buffer_load_dwordx4 v5, s[28:31], s46 offen lds
    v_mfma_f32_32x32x16_bf16 v[144:159], v[176:179], v[164:167], v[144:159]
    s_add_u32 s46, s46, 98304
    s_cmp_ge_u32 s46, 1966080
    s_cselect_b32 s21, s64, 0
    s_sub_u32 s46, s46, s21
    s_waitcnt vmcnt(5) lgkmcnt(0)
    s_barrier
    s_cmp_eq_u32 s47, 1
    s_cbranch_scc0 g_m1l_c1
g_m1l_chk:
    v_readfirstlane_b32 s70, v20
    v_xor_b32 v29, v20, v253
    v_xor_b32 v22, v20, v255
    v_or_b32 v29, v29, v22
    v_cmp_ne_u32 vcc, 0, v29
    s_cmp_eq_u32 s70, 0
    s_cbranch_scc1 g_m1l_slow
    s_nop 1
    s_cbranch_vccz g_m1l_fast
g_m1l_slow:
    s_sub_u32 s33, s33, 1
    s_cmp_eq_u32 s33, 0
    s_cbranch_scc1 g_m1l_fast
    s_sleep 4
    global_load_dword v20, v21, s[18:19] sc1
    buffer_load_dwordx2 v[252:253], v23, s[48:51], 0 offen sc1
    buffer_load_dwordx2 v[254:255], v23, s[48:51], 0 offen offset:512 sc1
    s_waitcnt vmcnt(0)
    s_branch g_m1l_chk
g_m1l_fast:
g_m1l_c1:
    v_mfma_f32_32x32x16_bf16 v[64:79], v[188:191], v[180:183], v[64:79]
    ds_read_b128 v[160:163], v6 offset:16384
    ds_read_b64_tr_b16 v[168:169], v8 offset:24576
    v_mfma_f32_32x32x16_bf16 v[80:95], v[188:191], v[184:187], v[80:95]
    v_mfma_f32_16x16x32_bf16 v[200:203], v[188:191], v[16:19], v[200:203]
    ds_read_b64_tr_b16 v[170:171], v8 offset:25344
    s_add_u32 m0, s40, 0
    ds_read_b128 v[164:167], v6 offset:20480
    buffer_load_dwordx4 v2, s[24:27], s45 offen lds
    v_mfma_f32_32x32x16_bf16 v[96:111], v[192:195], v[180:183], v[96:111]
    ds_read_b64_tr_b16 v[172:173], v9 offset:24576
    ds_read_b64_tr_b16 v[174:175], v9 offset:25344
    v_mfma_f32_32x32x16_bf16 v[112:127], v[192:195], v[184:187], v[112:127]
    v_mfma_f32_16x16x32_bf16 v[204:207], v[192:195], v[16:19], v[204:207]
    ds_read_b64_tr_b16 v[176:177], v10 offset:24576
    ds_read_b64_tr_b16 v[178:179], v10 offset:25344
    v_mfma_f32_32x32x16_bf16 v[128:143], v[196:199], v[180:183], v[128:143]
    s_add_u32 m0, s40, 1024
    s_nop 0
    buffer_load_dwordx4 v11, s[24:27], s45 offen lds
    v_mfma_f32_32x32x16_bf16 v[144:159], v[196:199], v[184:187], v[144:159]
    v_mfma_f32_16x16x32_bf16 v[208:211], v[196:199], v[16:19], v[208:211]
    s_add_u32 s45, s45, 128
    s_cmp_ge_u32 s45, 1280
    s_cselect_b32 s21, s65, 0
    s_sub_u32 s45, s45, s21
    s_waitcnt lgkmcnt(0)
    v_mfma_f32_32x32x16_bf16 v[64:79], v[168:171], v[160:163], v[64:79]
    ds_read_b128 v[180:183], v7 offset:16384
    s_add_u32 m0, s40, 2048
    ds_read_b64_tr_b16 v[188:189], v8 offset:27648
    buffer_load_dwordx4 v2, s[24:27], s35 offen lds
    v_mfma_f32_32x32x16_bf16 v[80:95], v[168:171], v[164:167], v[80:95]
    ds_read_b64_tr_b16 v[190:191], v8 offset:28416
    ds_read_b128 v[184:187], v7 offset:20480
    v_mfma_f32_32x32x16_bf16 v[96:111], v[172:175], v[160:163], v[96:111]
    ds_read_b64_tr_b16 v[192:193], v9 offset:27648
    s_add_u32 m0, s41, 12288
    ds_read_b64_tr_b16 v[194:195], v9 offset:28416
    buffer_load_dwordx4 v3, s[28:31], s46 offen lds
    v_mfma_f32_32x32x16_bf16 v[112:127], v[172:175], v[164:167], v[112:127]
    ds_read_b64_tr_b16 v[196:197], v10 offset:27648
    ds_read_b64_tr_b16 v[198:199], v10 offset:28416
    v_mfma_f32_32x32x16_bf16 v[128:143], v[176:179], v[160:163], v[128:143]
    s_add_u32 m0, s40, 3072
    s_nop 0
    buffer_load_dwordx4 v11, s[24:27], s35 offen lds
    v_mfma_f32_32x32x16_bf16 v[144:159], v[176:179], v[164:167], v[144:159]
    s_add_u32 s35, s35, 128
    s_cmp_ge_u32 s35, 21760
    s_cselect_b32 s21, s65, 0
    s_sub_u32 s35, s35, s21
    s_waitcnt vmcnt(8) lgkmcnt(0)
    s_barrier
    v_mfma_f32_32x32x16_bf16 v[64:79], v[188:191], v[180:183], v[64:79]
    ds_read_b128 v[160:163], v27 offset:16384
    ds_read_b64_tr_b16 v[168:169], v8 offset:36864
    v_mfma_f32_32x32x16_bf16 v[80:95], v[188:191], v[184:187], v[80:95]
    v_mfma_f32_16x16x32_bf16 v[200:203], v[188:191], v[16:19], v[200:203]
    ds_read_b64_tr_b16 v[170:171], v8 offset:37632
    s_add_u32 m0, s41, 13312
    ds_read_b128 v[164:167], v27 offset:20480
    buffer_load_dwordx4 v4, s[28:31], s46 offen lds
    v_mfma_f32_32x32x16_bf16 v[96:111], v[192:195], v[180:183], v[96:111]
    ds_read_b64_tr_b16 v[172:173], v9 offset:36864
    ds_read_b64_tr_b16 v[174:175], v9 offset:37632
    v_mfma_f32_32x32x16_bf16 v[112:127], v[192:195], v[184:187], v[112:127]
    v_mfma_f32_16x16x32_bf16 v[204:207], v[192:195], v[16:19], v[204:207]
    ds_read_b64_tr_b16 v[176:177], v10 offset:36864
    ds_read_b64_tr_b16 v[178:179], v10 offset:37632
    v_mfma_f32_32x32x16_bf16 v[128:143], v[196:199], v[180:183], v[128:143]
    s_add_u32 m0, s41, 14336
    s_nop 0
    buffer_load_dwordx4 v5, s[28:31], s46 offen lds
    v_mfma_f32_32x32x16_bf16 v[144:159], v[196:199], v[184:187], v[144:159]
    v_mfma_f32_16x16x32_bf16 v[208:211], v[196:199], v[16:19], v[208:211]
    s_add_u32 s46, s46, 98304
    s_cmp_ge_u32 s46, 1966080
    s_cselect_b32 s21, s64, 0
    s_sub_u32 s46, s46, s21
    s_waitcnt lgkmcnt(0)
    v_mfma_f32_32x32x16_bf16 v[64:79], v[168:171], v[160:163], v[64:79]
    ds_read_b128 v[180:183], v28 offset:16384
    s_add_u32 m0, s41, 24576
    ds_read_b64_tr_b16 v[188:189], v8 offset:39936
    buffer_load_dwordx4 v3, s[28:31], s46 offen lds
    v_mfma_f32_32x32x16_bf16 v[80:95], v[168:171], v[164:167], v[80:95]
    ds_read_b64_tr_b16 v[190:191], v8 offset:40704
    ds_read_b128 v[184:187], v28 offset:20480
    v_mfma_f32_32x32x16_bf16 v[96:111], v[172:175], v[160:163], v[96:111]
    ds_read_b64_tr_b16 v[192:193], v9 offset:39936
    s_add_u32 m0, s41, 25600
    ds_read_b64_tr_b16 v[194:195], v9 offset:40704
    buffer_load_dwordx4 v4, s[28:31], s46 offen lds
    v_mfma_f32_32x32x16_bf16 v[112:127], v[172:175], v[164:167], v[112:127]
    ds_read_b64_tr_b16 v[196:197], v10 offset:39936
    ds_read_b64_tr_b16 v[198:199], v10 offset:40704
    v_mfma_f32_32x32x16_bf16 v[128:143], v[176:179], v[160:163], v[128:143]
    s_add_u32 m0, s41, 26624
    s_nop 0
    buffer_load_dwordx4 v5, s[28:31], s46 offen lds
    v_mfma_f32_32x32x16_bf16 v[144:159], v[176:179], v[164:167], v[144:159]
    s_add_u32 s46, s46, 98304
    s_cmp_ge_u32 s46, 1966080
    s_cselect_b32 s21, s64, 0
    s_sub_u32 s46, s46, s21
    s_waitcnt vmcnt(5) lgkmcnt(0)
    s_barrier
    v_mfma_f32_32x32x16_bf16 v[64:79], v[188:191], v[180:183], v[64:79]
    ds_read_b128 v[160:163], v6 offset:0
    ds_read_b64_tr_b16 v[168:169], v8 offset:0
    v_mfma_f32_32x32x16_bf16 v[80:95], v[188:191], v[184:187], v[80:95]
    v_mfma_f32_16x16x32_bf16 v[200:203], v[188:191], v[16:19], v[200:203]
    ds_read_b64_tr_b16 v[170:171], v8 offset:768
    s_add_u32 m0, s40, 16384
    ds_read_b128 v[164:167], v6 offset:4096
    buffer_load_dwordx4 v2, s[24:27], s45 offen lds
    v_mfma_f32_32x32x16_bf16 v[96:111], v[192:195], v[180:183], v[96:111]
    ds_read_b64_tr_b16 v[172:173], v9 offset:0
    ds_read_b64_tr_b16 v[174:175], v9 offset:768
    v_mfma_f32_32x32x16_bf16 v[112:127], v[192:195], v[184:187], v[112:127]
    v_mfma_f32_16x16x32_bf16 v[204:207], v[192:195], v[16:19], v[204:207]
    ds_read_b64_tr_b16 v[176:177], v10 offset:0
    ds_read_b64_tr_b16 v[178:179], v10 offset:768
    v_mfma_f32_32x32x16_bf16 v[128:143], v[196:199], v[180:183], v[128:143]
    s_add_u32 m0, s40, 17408
    s_nop 0
    buffer_load_dwordx4 v11, s[24:27], s45 offen lds
    v_mfma_f32_32x32x16_bf16 v[144:159], v[196:199], v[184:187], v[144:159]
    v_mfma_f32_16x16x32_bf16 v[208:211], v[196:199], v[16:19], v[208:211]
    s_add_u32 s45, s45, 128
    s_cmp_ge_u32 s45, 1280
    s_cselect_b32 s21, s65, 0
    s_sub_u32 s45, s45, s21
    s_cmp_eq_u32 s47, 2
    s_cbranch_scc0 g_m1l_c2
    global_load_dword v20, v21, s[18:19] sc1
    buffer_load_dwordx2 v[252:253], v23, s[48:51], 0 offen sc1
    buffer_load_dwordx2 v[254:255], v23, s[48:51], 0 offen offset:512 sc1
g_m1l_c2:
    s_sub_u32 s47, s47, 1
    s_cmp_lg_u32 s47, 0
    s_cbranch_scc1 g_m1l_loop
    s_waitcnt lgkmcnt(0)
    v_mfma_f32_32x32x16_bf16 v[64:79], v[168:171], v[160:163], v[64:79]
    ds_read_b128 v[180:183], v7 offset:0
    s_add_u32 m0, s40, 18432
    ds_read_b64_tr_b16 v[188:189], v8 offset:3072
    buffer_load_dwordx4 v2, s[24:27], s35 offen lds
    v_mfma_f32_32x32x16_bf16 v[80:95], v[168:171], v[164:167], v[80:95]
    ds_read_b64_tr_b16 v[190:191], v8 offset:3840
    ds_read_b128 v[184:187], v7 offset:4096
    v_mfma_f32_32x32x16_bf16 v[96:111], v[172:175], v[160:163], v[96:111]
    ds_read_b64_tr_b16 v[192:193], v9 offset:3072
    s_add_u32 m0, s41, 36864
    ds_read_b64_tr_b16 v[194:195], v9 offset:3840
    buffer_load_dwordx4 v3, s[28:31], s46 offen lds
    v_mfma_f32_32x32x16_bf16 v[112:127], v[172:175], v[164:167], v[112:127]
    ds_read_b64_tr_b16 v[196:197], v10 offset:3072
    ds_read_b64_tr_b16 v[198:199], v10 offset:3840
    v_mfma_f32_32x32x16_bf16 v[128:143], v[176:179], v[160:163], v[128:143]
    s_add_u32 m0, s40, 19456
    s_nop 0
    buffer_load_dwordx4 v11, s[24:27], s35 offen lds
    v_mfma_f32_32x32x16_bf16 v[144:159], v[176:179], v[164:167], v[144:159]
    s_add_u32 s35, s35, 128
    s_cmp_ge_u32 s35, 21760
    s_cselect_b32 s21, s65, 0
    s_sub_u32 s35, s35, s21
    s_waitcnt vmcnt(8) lgkmcnt(0)
    s_barrier
    v_mfma_f32_32x32x16_bf16 v[64:79], v[188:191], v[180:183], v[64:79]
    ds_read_b128 v[160:163], v27 offset:0
    ds_read_b64_tr_b16 v[168:169], v8 offset:12288
    v_mfma_f32_32x32x16_bf16 v[80:95], v[188:191], v[184:187], v[80:95]
    v_mfma_f32_16x16x32_bf16 v[200:203], v[188:191], v[16:19], v[200:203]
    ds_read_b64_tr_b16 v[170:171], v8 offset:13056
    s_add_u32 m0, s41, 37888
    ds_read_b128 v[164:167], v27 offset:4096
    buffer_load_dwordx4 v4, s[28:31], s46 offen lds
    v_mfma_f32_32x32x16_bf16 v[96:111], v[192:195], v[180:183], v[96:111]
    ds_read_b64_tr_b16 v[172:173], v9 offset:12288
    ds_read_b64_tr_b16 v[174:175], v9 offset:13056
    v_mfma_f32_32x32x16_bf16 v[112:127], v[192:195], v[184:187], v[112:127]
    v_mfma_f32_16x16x32_bf16 v[204:207], v[192:195], v[16:19], v[204:207]
    ds_read_b64_tr_b16 v[176:177], v10 offset:12288
    ds_read_b64_tr_b16 v[178:179], v10 offset:13056
    v_mfma_f32_32x32x16_bf16 v[128:143], v[196:199], v[180:183], v[128:143]
    s_add_u32 m0, s41, 38912
    s_nop 0
    buffer_load_dwordx4 v5, s[28:31], s46 offen lds
    v_mfma_f32_32x32x16_bf16 v[144:159], v[196:199], v[184:187], v[144:159]
    v_mfma_f32_16x16x32_bf16 v[208:211], v[196:199], v[16:19], v[208:211]
    s_add_u32 s46, s46, 98304
    s_cmp_ge_u32 s46, 1966080
    s_cselect_b32 s21, s64, 0
    s_sub_u32 s46, s46, s21
    s_waitcnt lgkmcnt(0)
    v_mfma_f32_32x32x16_bf16 v[64:79], v[168:171], v[160:163], v[64:79]
    ds_read_b128 v[180:183], v28 offset:0
    ds_read_b64_tr_b16 v[188:189], v8 offset:15360
    v_mfma_f32_32x32x16_bf16 v[80:95], v[168:171], v[164:167], v[80:95]
    ds_read_b64_tr_b16 v[190:191], v8 offset:16128
    ds_read_b128 v[184:187], v28 offset:4096
    v_mfma_f32_32x32x16_bf16 v[96:111], v[172:175], v[160:163], v[96:111]
    ds_read_b64_tr_b16 v[192:193], v9 offset:15360
    ds_read_b64_tr_b16 v[194:195], v9 offset:16128
    v_mfma_f32_32x32x16_bf16 v[112:127], v[172:175], v[164:167], v[112:127]
    ds_read_b64_tr_b16 v[196:197], v10 offset:15360
    ds_read_b64_tr_b16 v[198:199], v10 offset:16128
    v_mfma_f32_32x32x16_bf16 v[128:143], v[176:179], v[160:163], v[128:143]
    v_mfma_f32_32x32x16_bf16 v[144:159], v[176:179], v[164:167], v[144:159]
    s_waitcnt vmcnt(2) lgkmcnt(0)
    s_barrier
    v_mfma_f32_32x32x16_bf16 v[64:79], v[188:191], v[180:183], v[64:79]
    ds_read_b128 v[160:163], v6 offset:16384
    ds_read_b64_tr_b16 v[168:169], v8 offset:24576
    v_mfma_f32_32x32x16_bf16 v[80:95], v[188:191], v[184:187], v[80:95]
    v_mfma_f32_16x16x32_bf16 v[200:203], v[188:191], v[16:19], v[200:203]
    ds_read_b64_tr_b16 v[170:171], v8 offset:25344
    ds_read_b128 v[164:167], v6 offset:20480
    v_mfma_f32_32x32x16_bf16 v[96:111], v[192:195], v[180:183], v[96:111]
    ds_read_b64_tr_b16 v[172:173], v9 offset:24576
    ds_read_b64_tr_b16 v[174:175], v9 offset:25344
    v_mfma_f32_32x32x16_bf16 v[112:127], v[192:195], v[184:187], v[112:127]
    v_mfma_f32_16x16x32_bf16 v[204:207], v[192:195], v[16:19], v[204:207]
    ds_read_b64_tr_b16 v[176:177], v10 offset:24576
    ds_read_b64_tr_b16 v[178:179], v10 offset:25344
    v_mfma_f32_32x32x16_bf16 v[128:143], v[196:199], v[180:183], v[128:143]
    v_mfma_f32_32x32x16_bf16 v[144:159], v[196:199], v[184:187], v[144:159]
    v_mfma_f32_16x16x32_bf16 v[208:211], v[196:199], v[16:19], v[208:211]
    s_waitcnt lgkmcnt(0)
    v_mfma_f32_32x32x16_bf16 v[64:79], v[168:171], v[160:163], v[64:79]
    ds_read_b128 v[180:183], v7 offset:16384
    ds_read_b64_tr_b16 v[188:189], v8 offset:27648
    v_mfma_f32_32x32x16_bf16 v[80:95], v[168:171], v[164:167], v[80:95]
    ds_read_b64_tr_b16 v[190:191], v8 offset:28416
    ds_read_b128 v[184:187], v7 offset:20480
    v_mfma_f32_32x32x16_bf16 v[96:111], v[172:175], v[160:163], v[96:111]
    ds_read_b64_tr_b16 v[192:193], v9 offset:27648
    ds_read_b64_tr_b16 v[194:195], v9 offset:28416
    v_mfma_f32_32x32x16_bf16 v[112:127], v[172:175], v[164:167], v[112:127]
    ds_read_b64_tr_b16 v[196:197], v10 offset:27648
    ds_read_b64_tr_b16 v[198:199], v10 offset:28416
    v_mfma_f32_32x32x16_bf16 v[128:143], v[176:179], v[160:163], v[128:143]
    v_mfma_f32_32x32x16_bf16 v[144:159], v[176:179], v[164:167], v[144:159]
    s_waitcnt vmcnt(0) lgkmcnt(0)
    s_barrier
    v_mfma_f32_32x32x16_bf16 v[64:79], v[188:191], v[180:183], v[64:79]
    ds_read_b128 v[160:163], v27 offset:16384
    ds_read_b64_tr_b16 v[168:169], v8 offset:36864
    v_mfma_f32_32x32x16_bf16 v[80:95], v[188:191], v[184:187], v[80:95]
    v_mfma_f32_16x16x32_bf16 v[200:203], v[188:191], v[16:19], v[200:203]
    ds_read_b64_tr_b16 v[170:171], v8 offset:37632
    ds_read_b128 v[164:167], v27 offset:20480
    v_mfma_f32_32x32x16_bf16 v[96:111], v[192:195], v[180:183], v[96:111]
    ds_read_b64_tr_b16 v[172:173], v9 offset:36864
    ds_read_b64_tr_b16 v[174:175], v9 offset:37632
    v_mfma_f32_32x32x16_bf16 v[112:127], v[192:195], v[184:187], v[112:127]
    v_mfma_f32_16x16x32_bf16 v[204:207], v[192:195], v[16:19], v[204:207]
    ds_read_b64_tr_b16 v[176:177], v10 offset:36864
    ds_read_b64_tr_b16 v[178:179], v10 offset:37632
    v_mfma_f32_32x32x16_bf16 v[128:143], v[196:199], v[180:183], v[128:143]
    v_mfma_f32_32x32x16_bf16 v[144:159], v[196:199], v[184:187], v[144:159]
    v_mfma_f32_16x16x32_bf16 v[208:211], v[196:199], v[16:19], v[208:211]
    s_waitcnt lgkmcnt(0)
    v_mfma_f32_32x32x16_bf16 v[64:79], v[168:171], v[160:163], v[64:79]
    ds_read_b128 v[180:183], v28 offset:16384
    ds_read_b64_tr_b16 v[188:189], v8 offset:39936
    v_mfma_f32_32x32x16_bf16 v[80:95], v[168:171], v[164:167], v[80:95]
    ds_read_b64_tr_b16 v[190:191], v8 offset:40704
    ds_read_b128 v[184:187], v28 offset:20480
    v_mfma_f32_32x32x16_bf16 v[96:111], v[172:175], v[160:163], v[96:111]
    ds_read_b64_tr_b16 v[192:193], v9 offset:39936
    ds_read_b64_tr_b16 v[194:195], v9 offset:40704
    v_mfma_f32_32x32x16_bf16 v[112:127], v[172:175], v[164:167], v[112:127]
    ds_read_b64_tr_b16 v[196:197], v10 offset:39936
    ds_read_b64_tr_b16 v[198:199], v10 offset:40704
    v_mfma_f32_32x32x16_bf16 v[128:143], v[176:179], v[160:163], v[128:143]
    v_mfma_f32_32x32x16_bf16 v[144:159], v[176:179], v[164:167], v[144:159]
    s_waitcnt lgkmcnt(0)
    v_mfma_f32_32x32x16_bf16 v[64:79], v[188:191], v[180:183], v[64:79]
    v_mfma_f32_32x32x16_bf16 v[80:95], v[188:191], v[184:187], v[80:95]
    v_mfma_f32_16x16x32_bf16 v[200:203], v[188:191], v[16:19], v[200:203]
    v_mfma_f32_32x32x16_bf16 v[96:111], v[192:195], v[180:183], v[96:111]
    v_mfma_f32_32x32x16_bf16 v[112:127], v[192:195], v[184:187], v[112:127]
    v_mfma_f32_16x16x32_bf16 v[204:207], v[192:195], v[16:19], v[204:207]
    v_mfma_f32_32x32x16_bf16 v[128:143], v[196:199], v[180:183], v[128:143]
    v_mfma_f32_32x32x16_bf16 v[144:159], v[196:199], v[184:187], v[144:159]
    v_mfma_f32_16x16x32_bf16 v[208:211], v[196:199], v[16:19], v[208:211]
g_mdone:
    s_add_u32 s28, s4, 5898240
    s_addc_u32 s29, s5, 0
    s_mov_b32 s30, 1966080
    s_mov_b32 s31, 0x00020000
    s_lshr_b32 s20, s3, 5
    v_min_u32 v33, 23, v1
    v_lshlrev_b32 v33, 3, v33
    v_add_u32 v33, s20, v33
    v_lshlrev_b32 v33, 7, v33
    s_mov_b32 s20, 180224
    buffer_load_dword v34, v33, s[72:75], s20 offen sc1
    v_and_b32 v13, 15, v1
    v_lshrrev_b32 v14, 4, v1
    v_lshlrev_b32 v13, 6, v13
    v_lshl_add_u32 v13, v14, 4, v13
    s_mul_i32 s20, s62, 384
    v_add_u32 v13, s20, v13
    s_mov_b32 exec_lo, 0x00030003
    s_mov_b32 exec_hi, 0x00030003
    ds_write_b128 v13, v[200:203] offset:0
    ds_write_b128 v13, v[204:207] offset:128
    ds_write_b128 v13, v[208:211] offset:256
    s_mov_b64 exec, -1
    v_and_b32 v16, 31, v1
    v_lshlrev_b32 v16, 2, v16
    v_add_u32 v17, s20, v16
    s_xor_b32 s21, s62, 2
    s_mul_i32 s21, s21, 384
    v_add_u32 v18, s21, v16
    v_mov_b32 v160, 0
    v_mov_b32 v161, 0
    v_mov_b32 v162, 0
    v_mov_b32 v163, 0
    v_mov_b32 v164, 0
    v_mov_b32 v165, 0
    v_mov_b32 v166, 0
    v_mov_b32 v167, 0
    v_mov_b32 v168, 0
    v_mov_b32 v169, 0
    v_mov_b32 v170, 0
    v_mov_b32 v171, 0
    v_mov_b32 v172, 0
    v_mov_b32 v173, 0
    v_mov_b32 v174, 0
    v_mov_b32 v175, 0
    v_mov_b32 v176, 0
    v_mov_b32 v177, 0
    v_mov_b32 v178, 0
    v_mov_b32 v179, 0
    v_and_b32 v253, 0xffff0000, v252
    v_mul_f32 v189, v253, v253
    v_rcp_f32 v253, v253
    v_and_b32 v180, 0xffff, v252
    v_xor_b32 v180, 0x8000, v180
    v_mul_f32 v188, 0xbfb8aa3b, v253
    s_mov_b32 exec_hi, 0
    v_lshl_or_b32 v172, v180, 16, v180
    v_mov_b32 v173, v172
    s_mov_b32 exec_hi, -1
    v_and_b32 v255, 0xffff0000, v254
    v_mul_f32 v191, v255, v255
    v_rcp_f32 v255, v255
    v_and_b32 v180, 0xffff, v254
    v_xor_b32 v180, 0x8000, v180
    v_mul_f32 v190, 0xbfb8aa3b, v255
    s_mov_b32 exec_hi, 0
    v_lshl_or_b32 v176, v180, 16, v180
    v_mov_b32 v177, v176
    s_mov_b32 exec_hi, -1
    s_waitcnt lgkmcnt(0)
    s_barrier
    ds_read_b32 v180, v17 offset:0
    ds_read_b32 v181, v18 offset:0
    ds_read_b32 v182, v17 offset:128
    ds_read_b32 v183, v18 offset:128
    ds_read_b32 v184, v17 offset:256
    ds_read_b32 v185, v18 offset:256
    v_and_b32 v13, 31, v1
    v_lshrrev_b32 v14, 5, v1
    v_lshrrev_b32 v15, 4, v13
    v_mul_u32_u24 v15, 49152, v15
    v_and_b32 v13, 15, v13
    v_lshl_add_u32 v13, v14, 4, v13
    v_lshl_add_u32 v13, v13, 4, v15
    s_lshl_b32 s20, s60, 3
    s_lshl_b32 s21, s43, 2
    s_add_u32 s20, s20, s21
    s_mul_i32 s20, s20, 49152
    s_mul_i32 s21, s61, 6
    s_mul_i32 s22, s44, 3
    s_add_u32 s21, s21, s22
    s_waitcnt lgkmcnt(0)
    s_mov_b32 exec_hi, 0
    v_cvt_pk_bf16_f32 v186, v180, v180
    v_lshlrev_b32 v186, 16, v186
    v_sub_f32 v186, v180, v186
    v_cvt_pk_bf16_f32 v160, v180, v186
    v_cvt_pk_bf16_f32 v186, v181, v181
    v_lshlrev_b32 v186, 16, v186
    v_sub_f32 v186, v181, v186
    v_cvt_pk_bf16_f32 v161, v181, v186
    v_cvt_pk_bf16_f32 v186, v182, v182
    v_lshlrev_b32 v186, 16, v186
    v_sub_f32 v186, v182, v186
    v_cvt_pk_bf16_f32 v164, v182, v186
    v_cvt_pk_bf16_f32 v186, v183, v183
    v_lshlrev_b32 v186, 16, v186
    v_sub_f32 v186, v183, v186
    v_cvt_pk_bf16_f32 v165, v183, v186
    v_cvt_pk_bf16_f32 v186, v184, v184
    v_lshlrev_b32 v186, 16, v186
    v_sub_f32 v186, v184, v186
    v_cvt_pk_bf16_f32 v168, v184, v186
    v_cvt_pk_bf16_f32 v186, v185, v185
    v_lshlrev_b32 v186, 16, v186
    v_sub_f32 v186, v185, v186
    v_cvt_pk_bf16_f32 v169, v185, v186
    s_mov_b32 exec_hi, -1
    s_nop 3
    v_mfma_f32_32x32x16_bf16 v[64:79], v[160:163], v[172:175], v[64:79]
    v_mfma_f32_32x32x16_bf16 v[80:95], v[160:163], v[176:179], v[80:95]
    v_mfma_f32_32x32x16_bf16 v[96:111], v[164:167], v[172:175], v[96:111]
    v_mfma_f32_32x32x16_bf16 v[112:127], v[164:167], v[176:179], v[112:127]
    v_mfma_f32_32x32x16_bf16 v[128:143], v[168:171], v[172:175], v[128:143]
    v_mfma_f32_32x32x16_bf16 v[144:159], v[168:171], v[176:179], v[144:159]
    s_add_u32 s22, s21, 0
    s_lshr_b32 s23, s22, 1
    s_lshl_b32 s23, s23, 10
    s_and_b32 s22, s22, 1
    s_lshl_b32 s22, s22, 9
    s_add_u32 s23, s23, s22
    s_add_u32 s23, s23, s20
    v_mul_f32 v200, v188, v64
    v_mul_f32 v201, v188, v65
    v_mul_f32 v202, v188, v66
    v_mul_f32 v203, v188, v67
    v_exp_f32 v200, v200
    v_exp_f32 v201, v201
    v_exp_f32 v202, v202
    v_exp_f32 v203, v203
    v_mul_f32 v64, v64, v72
    v_mul_f32 v65, v65, v73
    v_mul_f32 v66, v66, v74
    v_mul_f32 v67, v67, v75
    v_fma_f32 v200, v200, v189, v189
    v_fma_f32 v201, v201, v189, v189
    v_fma_f32 v202, v202, v189, v189
    v_fma_f32 v203, v203, v189, v189
    v_rcp_f32 v200, v200
    v_rcp_f32 v201, v201
    v_rcp_f32 v202, v202
    v_rcp_f32 v203, v203
    v_mul_f32 v64, v64, v200
    v_mul_f32 v65, v65, v201
    v_mul_f32 v66, v66, v202
    v_mul_f32 v67, v67, v203
    v_cvt_pk_bf16_f32 v208, v64, v65
    v_cvt_pk_bf16_f32 v209, v66, v67
    v_mul_f32 v200, v188, v68
    v_mul_f32 v201, v188, v69
    v_mul_f32 v202, v188, v70
    v_mul_f32 v203, v188, v71
    v_exp_f32 v200, v200
    v_exp_f32 v201, v201
    v_exp_f32 v202, v202
    v_exp_f32 v203, v203
    v_mul_f32 v68, v68, v76
    v_mul_f32 v69, v69, v77
    v_mul_f32 v70, v70, v78
    v_mul_f32 v71, v71, v79
    v_fma_f32 v200, v200, v189, v189
    v_fma_f32 v201, v201, v189, v189
    v_fma_f32 v202, v202, v189, v189
    v_fma_f32 v203, v203, v189, v189
    v_rcp_f32 v200, v200
    v_rcp_f32 v201, v201
    v_rcp_f32 v202, v202
    v_rcp_f32 v203, v203
    v_mul_f32 v68, v68, v200
    v_mul_f32 v69, v69, v201
    v_mul_f32 v70, v70, v202
    v_mul_f32 v71, v71, v203
    v_cvt_pk_bf16_f32 v210, v68, v69
    v_cvt_pk_bf16_f32 v211, v70, v71
    buffer_store_dwordx4 v[208:211], v13, s[36:39], s23 offen sc1
    v_mul_f32 v200, v190, v80
    v_mul_f32 v201, v190, v81
    v_mul_f32 v202, v190, v82
    v_mul_f32 v203, v190, v83
    v_exp_f32 v200, v200
    v_exp_f32 v201, v201
    v_exp_f32 v202, v202
    v_exp_f32 v203, v203
    v_mul_f32 v80, v80, v88
    v_mul_f32 v81, v81, v89
    v_mul_f32 v82, v82, v90
    v_mul_f32 v83, v83, v91
    v_fma_f32 v200, v200, v191, v191
    v_fma_f32 v201, v201, v191, v191
    v_fma_f32 v202, v202, v191, v191
    v_fma_f32 v203, v203, v191, v191
    v_rcp_f32 v200, v200
    v_rcp_f32 v201, v201
    v_rcp_f32 v202, v202
    v_rcp_f32 v203, v203
    v_mul_f32 v80, v80, v200
    v_mul_f32 v81, v81, v201
    v_mul_f32 v82, v82, v202
    v_mul_f32 v83, v83, v203
    v_cvt_pk_bf16_f32 v212, v80, v81
    v_cvt_pk_bf16_f32 v213, v82, v83
    v_mul_f32 v200, v190, v84
    v_mul_f32 v201, v190, v85
    v_mul_f32 v202, v190, v86
    v_mul_f32 v203, v190, v87
    v_exp_f32 v200, v200
    v_exp_f32 v201, v201
    v_exp_f32 v202, v202
    v_exp_f32 v203, v203
    v_mul_f32 v84, v84, v92
    v_mul_f32 v85, v85, v93
    v_mul_f32 v86, v86, v94
    v_mul_f32 v87, v87, v95
    v_fma_f32 v200, v200, v191, v191
    v_fma_f32 v201, v201, v191, v191
    v_fma_f32 v202, v202, v191, v191
    v_fma_f32 v203, v203, v191, v191
    v_rcp_f32 v200, v200
    v_rcp_f32 v201, v201
    v_rcp_f32 v202, v202
    v_rcp_f32 v203, v203
    v_mul_f32 v84, v84, v200
    v_mul_f32 v85, v85, v201
    v_mul_f32 v86, v86, v202
    v_mul_f32 v87, v87, v203
    v_cvt_pk_bf16_f32 v214, v84, v85
    v_cvt_pk_bf16_f32 v215, v86, v87
    s_add_u32 s32, s23, 98304
    buffer_store_dwordx4 v[212:215], v13, s[36:39], s32 offen sc1
    s_add_u32 s22, s21, 1
    s_lshr_b32 s23, s22, 1
    s_lshl_b32 s23, s23, 10
    s_and_b32 s22, s22, 1
    s_lshl_b32 s22, s22, 9
    s_add_u32 s23, s23, s22
    s_add_u32 s23, s23, s20
    v_mul_f32 v200, v188, v96
    v_mul_f32 v201, v188, v97
    v_mul_f32 v202, v188, v98
    v_mul_f32 v203, v188, v99
    v_exp_f32 v200, v200
    v_exp_f32 v201, v201
    v_exp_f32 v202, v202
    v_exp_f32 v203, v203
    v_mul_f32 v96, v96, v104
    v_mul_f32 v97, v97, v105
    v_mul_f32 v98, v98, v106
    v_mul_f32 v99, v99, v107
    v_fma_f32 v200, v200, v189, v189
    v_fma_f32 v201, v201, v189, v189
    v_fma_f32 v202, v202, v189, v189
    v_fma_f32 v203, v203, v189, v189
    v_rcp_f32 v200, v200
    v_rcp_f32 v201, v201
    v_rcp_f32 v202, v202
    v_rcp_f32 v203, v203
    v_mul_f32 v96, v96, v200
    v_mul_f32 v97, v97, v201
    v_mul_f32 v98, v98, v202
    v_mul_f32 v99, v99, v203
    v_cvt_pk_bf16_f32 v208, v96, v97
    v_cvt_pk_bf16_f32 v209, v98, v99
    v_mul_f32 v200, v188, v100
    v_mul_f32 v201, v188, v101
    v_mul_f32 v202, v188, v102
    v_mul_f32 v203, v188, v103
    v_exp_f32 v200, v200
    v_exp_f32 v201, v201
    v_exp_f32 v202, v202
    v_exp_f32 v203, v203
    v_mul_f32 v100, v100, v108
    v_mul_f32 v101, v101, v109
    v_mul_f32 v102, v102, v110
    v_mul_f32 v103, v103, v111
    v_fma_f32 v200, v200, v189, v189
    v_fma_f32 v201, v201, v189, v189
    v_fma_f32 v202, v202, v189, v189
    v_fma_f32 v203, v203, v189, v189
    v_rcp_f32 v200, v200
    v_rcp_f32 v201, v201
    v_rcp_f32 v202, v202
    v_rcp_f32 v203, v203
    v_mul_f32 v100, v100, v200
    v_mul_f32 v101, v101, v201
    v_mul_f32 v102, v102, v202
    v_mul_f32 v103, v103, v203
    v_cvt_pk_bf16_f32 v210, v100, v101
    v_cvt_pk_bf16_f32 v211, v102, v103
    buffer_store_dwordx4 v[208:211], v13, s[36:39], s23 offen sc1
    v_mul_f32 v200, v190, v112
    v_mul_f32 v201, v190, v113
    v_mul_f32 v202, v190, v114
    v_mul_f32 v203, v190, v115
    v_exp_f32 v200, v200
    v_exp_f32 v201, v201
    v_exp_f32 v202, v202
    v_exp_f32 v203, v203
    v_mul_f32 v112, v112, v120
    v_mul_f32 v113, v113, v121
    v_mul_f32 v114, v114, v122
    v_mul_f32 v115, v115, v123
    v_fma_f32 v200, v200, v191, v191
    v_fma_f32 v201, v201, v191, v191
    v_fma_f32 v202, v202, v191, v191
    v_fma_f32 v203, v203, v191, v191
    v_rcp_f32 v200, v200
    v_rcp_f32 v201, v201
    v_rcp_f32 v202, v202
    v_rcp_f32 v203, v203
    v_mul_f32 v112, v112, v200
    v_mul_f32 v113, v113, v201
    v_mul_f32 v114, v114, v202
    v_mul_f32 v115, v115, v203
    v_cvt_pk_bf16_f32 v212, v112, v113
    v_cvt_pk_bf16_f32 v213, v114, v115
    v_mul_f32 v200, v190, v116
    v_mul_f32 v201, v190, v117
    v_mul_f32 v202, v190, v118
    v_mul_f32 v203, v190, v119
    v_exp_f32 v200, v200
    v_exp_f32 v201, v201
    v_exp_f32 v202, v202
    v_exp_f32 v203, v203
    v_mul_f32 v116, v116, v124
    v_mul_f32 v117, v117, v125
    v_mul_f32 v118, v118, v126
    v_mul_f32 v119, v119, v127
    v_fma_f32 v200, v200, v191, v191
    v_fma_f32 v201, v201, v191, v191
    v_fma_f32 v202, v202, v191, v191
    v_fma_f32 v203, v203, v191, v191
    v_rcp_f32 v200, v200
    v_rcp_f32 v201, v201
    v_rcp_f32 v202, v202
    v_rcp_f32 v203, v203
    v_mul_f32 v116, v116, v200
    v_mul_f32 v117, v117, v201
    v_mul_f32 v118, v118, v202
    v_mul_f32 v119, v119, v203
    v_cvt_pk_bf16_f32 v214, v116, v117
    v_cvt_pk_bf16_f32 v215, v118, v119
    s_add_u32 s32, s23, 98304
    buffer_store_dwordx4 v[212:215], v13, s[36:39], s32 offen sc1
    s_add_u32 s22, s21, 2
    s_lshr_b32 s23, s22, 1
    s_lshl_b32 s23, s23, 10
    s_and_b32 s22, s22, 1
    s_lshl_b32 s22, s22, 9
    s_add_u32 s23, s23, s22
    s_add_u32 s23, s23, s20
    v_mul_f32 v200, v188, v128
    v_mul_f32 v201, v188, v129
    v_mul_f32 v202, v188, v130
    v_mul_f32 v203, v188, v131
    v_exp_f32 v200, v200
    v_exp_f32 v201, v201
    v_exp_f32 v202, v202
    v_exp_f32 v203, v203
    v_mul_f32 v128, v128, v136
    v_mul_f32 v129, v129, v137
    v_mul_f32 v130, v130, v138
    v_mul_f32 v131, v131, v139
    v_fma_f32 v200, v200, v189, v189
    v_fma_f32 v201, v201, v189, v189
    v_fma_f32 v202, v202, v189, v189
    v_fma_f32 v203, v203, v189, v189
    v_rcp_f32 v200, v200
    v_rcp_f32 v201, v201
    v_rcp_f32 v202, v202
    v_rcp_f32 v203, v203
    v_mul_f32 v128, v128, v200
    v_mul_f32 v129, v129, v201
    v_mul_f32 v130, v130, v202
    v_mul_f32 v131, v131, v203
    v_cvt_pk_bf16_f32 v208, v128, v129
    v_cvt_pk_bf16_f32 v209, v130, v131
    v_mul_f32 v200, v188, v132
    v_mul_f32 v201, v188, v133
    v_mul_f32 v202, v188, v134
    v_mul_f32 v203, v188, v135
    v_exp_f32 v200, v200
    v_exp_f32 v201, v201
    v_exp_f32 v202, v202
    v_exp_f32 v203, v203
    v_mul_f32 v132, v132, v140
    v_mul_f32 v133, v133, v141
    v_mul_f32 v134, v134, v142
    v_mul_f32 v135, v135, v143
    v_fma_f32 v200, v200, v189, v189
    v_fma_f32 v201, v201, v189, v189
    v_fma_f32 v202, v202, v189, v189
    v_fma_f32 v203, v203, v189, v189
    v_rcp_f32 v200, v200
    v_rcp_f32 v201, v201
    v_rcp_f32 v202, v202
    v_rcp_f32 v203, v203
    v_mul_f32 v132, v132, v200
    v_mul_f32 v133, v133, v201
    v_mul_f32 v134, v134, v202
    v_mul_f32 v135, v135, v203
    v_cvt_pk_bf16_f32 v210, v132, v133
    v_cvt_pk_bf16_f32 v211, v134, v135
    buffer_store_dwordx4 v[208:211], v13, s[36:39], s23 offen sc1
    v_mul_f32 v200, v190, v144
    v_mul_f32 v201, v190, v145
    v_mul_f32 v202, v190, v146
    v_mul_f32 v203, v190, v147
    v_exp_f32 v200, v200
    v_exp_f32 v201, v201
    v_exp_f32 v202, v202
    v_exp_f32 v203, v203
    v_mul_f32 v144, v144, v152
    v_mul_f32 v145, v145, v153
    v_mul_f32 v146, v146, v154
    v_mul_f32 v147, v147, v155
    v_fma_f32 v200, v200, v191, v191
    v_fma_f32 v201, v201, v191, v191
    v_fma_f32 v202, v202, v191, v191
    v_fma_f32 v203, v203, v191, v191
    v_rcp_f32 v200, v200
    v_rcp_f32 v201, v201
    v_rcp_f32 v202, v202
    v_rcp_f32 v203, v203
    v_mul_f32 v144, v144, v200
    v_mul_f32 v145, v145, v201
    v_mul_f32 v146, v146, v202
    v_mul_f32 v147, v147, v203
    v_cvt_pk_bf16_f32 v212, v144, v145
    v_cvt_pk_bf16_f32 v213, v146, v147
    v_mul_f32 v200, v190, v148
    v_mul_f32 v201, v190, v149
    v_mul_f32 v202, v190, v150
    v_mul_f32 v203, v190, v151
    v_exp_f32 v200, v200
    v_exp_f32 v201, v201
    v_exp_f32 v202, v202
    v_exp_f32 v203, v203
    v_mul_f32 v148, v148, v156
    v_mul_f32 v149, v149, v157
    v_mul_f32 v150, v150, v158
    v_mul_f32 v151, v151, v159
    v_fma_f32 v200, v200, v191, v191
    v_fma_f32 v201, v201, v191, v191
    v_fma_f32 v202, v202, v191, v191
    v_fma_f32 v203, v203, v191, v191
    v_rcp_f32 v200, v200
    v_rcp_f32 v201, v201
    v_rcp_f32 v202, v202
    v_rcp_f32 v203, v203
    v_mul_f32 v148, v148, v200
    v_mul_f32 v149, v149, v201
    v_mul_f32 v150, v150, v202
    v_mul_f32 v151, v151, v203
    v_cvt_pk_bf16_f32 v214, v148, v149
    v_cvt_pk_bf16_f32 v215, v150, v151
    s_add_u32 s32, s23, 98304
    buffer_store_dwordx4 v[212:215], v13, s[36:39], s32 offen sc1
    s_lshl_b32 s19, s60, 4
    s_add_u32 s19, s19, s61
    s_lshl_b32 s19, s19, 7
    s_add_u32 s19, s19, 32768
    s_and_b32 s20, s3, 7
    s_lshr_b32 s21, s3, 3
    s_lshl_b32 s20, s20, 2
    s_and_b32 s22, s21, 3
    s_add_u32 s60, s20, s22
    s_lshr_b32 s61, s21, 2
    s_mov_b32 s32, s14
    s_mov_b32 s33, s15
    s_mov_b32 s34, 2621440
    s_mov_b32 s35, 0x00020000
    s_add_u32 s52, s4, 3145728
    s_addc_u32 s53, s5, 0
    s_mov_b32 s54, 2703360
    s_mov_b32 s55, 0x00020000
    s_mov_b32 s56, s16
    s_mov_b32 s57, s17
    s_mov_b32 s58, 1280
    s_mov_b32 s59, 0x00020000
    s_and_b32 s43, s62, 1
    s_lshr_b32 s44, s62, 1
    v_lshlrev_b32 v2, 4, v1
    s_lshl_b32 s20, s60, 2
    s_add_u32 s20, s20, s62
    s_mul_i32 s20, s20, 49152
    v_add_u32 v2, s20, v2
    s_lshl_b32 s40, s62, 10
    s_lshl_b32 s20, s43, 1
    s_mul_i32 s21, s43, 3
    s_add_u32 s21, s21, 4
    s_cmp_eq_u32 s44, 0
    s_cselect_b32 s20, s20, s21
    s_lshl_b32 s41, s20, 10
    s_add_u32 s41, s41, 8192
    s_lshl_b32 s20, s20, 10
    s_mul_i32 s23, s61, 245760
    s_add_u32 s20, s20, s23
    v_lshlrev_b32 v3, 4, v1
    v_add_u32 v3, s20, v3
    s_lshr_b32 s20, s3, 3
    s_and_b32 s20, s20, 3
    s_mul_i32 s20, s20, 6
    s_mul_i32 s21, s61, 3
    s_add_u32 s20, s20, s21
    s_cmp_ge_u32 s20, 24
    s_cselect_b32 s21, 24, 0
    s_sub_u32 s67, s20, s21
    s_mov_b32 s64, 49152
    s_mov_b32 s65, 245760
    v_lshlrev_b32 v6, 4, v1
    s_lshl_b32 s20, s43, 11
    v_add_u32 v6, s20, v6
    v_bfe_u32 v13, v1, 5, 1
    v_lshlrev_b32 v13, 4, v13
    v_bfe_u32 v14, v1, 4, 1
    v_lshl_add_u32 v13, v14, 2, v13
    v_bfe_u32 v14, v1, 2, 2
    v_add_u32 v13, v13, v14
    v_mul_u32_u24 v13, 160, v13
    v_and_b32 v14, 3, v1
    v_lshl_add_u32 v13, v14, 3, v13
    s_mul_i32 s20, s44, 96
    s_add_u32 s20, s20, 8192
    v_add_u32 v7, s20, v13
    v_mov_b32 v64, 0
    v_mov_b32 v65, 0
    v_mov_b32 v66, 0
    v_mov_b32 v67, 0
    v_mov_b32 v68, 0
    v_mov_b32 v69, 0
    v_mov_b32 v70, 0
    v_mov_b32 v71, 0
    v_mov_b32 v72, 0
    v_mov_b32 v73, 0
    v_mov_b32 v74, 0
    v_mov_b32 v75, 0
    v_mov_b32 v76, 0
    v_mov_b32 v77, 0
    v_mov_b32 v78, 0
    v_mov_b32 v79, 0
    v_mov_b32 v80, 0
    v_mov_b32 v81, 0
    v_mov_b32 v82, 0
    v_mov_b32 v83, 0
    v_mov_b32 v84, 0
    v_mov_b32 v85, 0
    v_mov_b32 v86, 0
    v_mov_b32 v87, 0
    s_cmp_eq_u32 s44, 0
    s_cbranch_scc0 g_b
    v_and_b32 v14, 15, v1
    v_lshrrev_b32 v15, 4, v1
    s_lshl_b32 s21, s60, 6
    s_lshl_b32 s23, s43, 5
    s_add_u32 s21, s21, s23
    v_add_u32 v14, s21, v14
    v_mov_b32 v16, v14
    v_and_b32 v17, 7, v16
    v_lshrrev_b32 v16, 3, v16
    v_lshlrev_b32 v16, 7, v16
    v_lshl_add_u32 v16, v17, 3, v16
    v_mul_u32_u24 v14, 1280, v14
    v_lshl_add_u32 v14, v15, 3, v14
    s_mul_i32 s20, s61, 80
    s_mul_i32 s21, s44, 48
    s_add_u32 s20, s20, s21
    s_lshl_b32 s22, s20, 1
    v_add_u32 v14, s22, v14
    v_lshlrev_b32 v15, 3, v15
    v_add_u32 v15, s22, v15
    v_lshrrev_b32 v13, 2, v1
    v_add_u32 v13, s20, v13
    v_mul_u32_u24 v13, 4224, v13
    v_and_b32 v17, 3, v1
    v_lshl_add_u32 v10, v17, 4, v13
    v_cmp_gt_u32 vcc, 48, v1
    s_nop 1
    v_cndmask_b32 v11, 0, v1, vcc
    v_add_u32 v11, s20, v11
    v_lshlrev_b32 v11, 7, v11
    v_and_b32 v17, 15, v1
    s_lshr_b32 s21, s60, 1
    s_lshl_b32 s21, s21, 4
    v_add_u32 v17, s21, v17
    v_lshlrev_b32 v17, 7, v17
    v_lshlrev_b32 v13, 7, v1
    s_waitcnt vmcnt(0)
    s_barrier
    v_cmp_ne_u32 vcc, s70, v34
    s_nop 4
    s_cbranch_vccz g_2a_wok
    s_mov_b32 s20, 4096
    s_mov_b32 s21, 180224
g_2a_pw_pl:
    buffer_load_dword v34, v33, s[72:75], s21 offen sc1
    s_waitcnt vmcnt(0)
    v_xor_b32 v34, s70, v34
    v_cmp_ne_u32 vcc, 0, v34
    s_sub_u32 s20, s20, 1
    s_cmp_eq_u32 s20, 0
    s_cbranch_scc1 g_2a_pw_pd
    s_nop 1
    s_cbranch_vccz g_2a_pw_pd
    s_sleep 4
    s_branch g_2a_pw_pl
g_2a_pw_pd:
g_2a_wok:
    s_cmp_eq_u32 s62, 0
    s_cbranch_scc0 g_2a_w1
    v_mov_b32 v18, s70
    v_mov_b32 v19, 0
    s_mov_b64 exec, 1
    buffer_store_dword v18, v19, s[72:75], s19 offen sc1
    s_mov_b64 exec, -1
g_2a_w1:
    s_add_u32 s20, s67, 0
    s_cmp_ge_u32 s20, 24
    s_cselect_b32 s21, 24, 0
    s_sub_u32 s20, s20, s21
    s_lshl_b32 s45, s20, 11
    s_mul_i32 s46, s20, 10240
    s_add_u32 m0, s41, 0
    s_nop 0
    buffer_load_dwordx4 v3, s[28:31], s46 offen offset:0 sc1 lds
    s_add_u32 m0, s41, 0
    s_nop 0
    buffer_load_dwordx4 v3, s[28:31], s46 offen offset:1024 sc1 lds
    s_add_u32 s20, s67, 1
    s_cmp_ge_u32 s20, 24
    s_cselect_b32 s21, 24, 0
    s_sub_u32 s20, s20, s21
    s_lshl_b32 s45, s20, 11
    s_mul_i32 s46, s20, 10240
    s_add_u32 m0, s41, 18432
    s_nop 0
    buffer_load_dwordx4 v3, s[28:31], s46 offen offset:0 sc1 lds
    s_add_u32 m0, s41, 18432
    s_nop 0
    buffer_load_dwordx4 v3, s[28:31], s46 offen offset:1024 sc1 lds
    s_add_u32 s20, s67, 2
    s_cmp_ge_u32 s20, 24
    s_cselect_b32 s21, 24, 0
    s_sub_u32 s20, s20, s21
    s_lshl_b32 s45, s20, 11
    s_mul_i32 s46, s20, 10240
    s_add_u32 m0, s41, 36864
    s_nop 0
    buffer_load_dwordx4 v3, s[28:31], s46 offen offset:0 sc1 lds
    s_add_u32 m0, s41, 36864
    s_nop 0
    buffer_load_dwordx4 v3, s[28:31], s46 offen offset:1024 sc1 lds
    s_add_u32 s20, s67, 3
    s_cmp_ge_u32 s20, 24
    s_cselect_b32 s21, 24, 0
    s_sub_u32 s20, s20, s21
    s_lshl_b32 s45, s20, 11
    s_mul_i32 s46, s20, 10240
    s_add_u32 m0, s41, 55296
    s_nop 0
    buffer_load_dwordx4 v3, s[28:31], s46 offen offset:0 sc1 lds
    s_add_u32 m0, s41, 55296
    s_nop 0
    buffer_load_dwordx4 v3, s[28:31], s46 offen offset:1024 sc1 lds
    buffer_load_dwordx2 v[160:161], v15, s[56:59], 0 offen offset:0
    s_mov_b32 s23, 0
    buffer_load_dwordx2 v[136:137], v14, s[24:27], s23 offen offset:0
    s_mov_b32 s23, 20480
    buffer_load_dwordx2 v[138:139], v14, s[24:27], s23 offen offset:0
    buffer_load_dwordx2 v[162:163], v15, s[56:59], 0 offen offset:32
    s_mov_b32 s23, 0
    buffer_load_dwordx2 v[140:141], v14, s[24:27], s23 offen offset:32
    s_mov_b32 s23, 20480
    buffer_load_dwordx2 v[142:143], v14, s[24:27], s23 offen offset:32
    buffer_load_dwordx2 v[164:165], v15, s[56:59], 0 offen offset:64
    s_mov_b32 s23, 0
    buffer_load_dwordx2 v[144:145], v14, s[24:27], s23 offen offset:64
    s_mov_b32 s23, 20480
    buffer_load_dwordx2 v[146:147], v14, s[24:27], s23 offen offset:64
    s_cmp_eq_u32 s62, 0
    s_cbranch_scc0 g_2a_w2
    s_mov_b32 s20, 4096
    s_mov_b32 s21, 32768
g_2a_ph_pl:
    buffer_load_dword v18, v17, s[72:75], s21 offen sc1
    s_waitcnt vmcnt(0)
    v_xor_b32 v18, s70, v18
    v_cmp_ne_u32 vcc, 0, v18
    s_sub_u32 s20, s20, 1
    s_cmp_eq_u32 s20, 0
    s_cbranch_scc1 g_2a_ph_pd
    s_nop 1
    s_cbranch_vccz g_2a_ph_pd
    s_sleep 4
    s_branch g_2a_ph_pl
g_2a_ph_pd:
g_2a_w2:
    s_barrier
    buffer_load_dwordx2 v[168:169], v16, s[48:51], 0 offen sc1
    buffer_load_dwordx2 v[170:171], v16, s[48:51], 0 offen offset:256 sc1
    s_add_u32 s20, s67, 0
    s_cmp_ge_u32 s20, 24
    s_cselect_b32 s21, 24, 0
    s_sub_u32 s20, s20, s21
    s_lshl_b32 s45, s20, 11
    s_mul_i32 s46, s20, 10240
    s_add_u32 m0, s40, 0
    s_nop 0
    buffer_load_dwordx4 v2, s[36:39], s45 offen sc1 lds
    s_add_u32 m0, s40, 4096
    s_add_u32 s47, s45, 1024
    buffer_load_dwordx4 v2, s[36:39], s47 offen sc1 lds
    s_add_u32 s20, s67, 1
    s_cmp_ge_u32 s20, 24
    s_cselect_b32 s21, 24, 0
    s_sub_u32 s20, s20, s21
    s_lshl_b32 s45, s20, 11
    s_mul_i32 s46, s20, 10240
    s_add_u32 m0, s40, 18432
    s_nop 0
    buffer_load_dwordx4 v2, s[36:39], s45 offen sc1 lds
    s_add_u32 m0, s40, 22528
    s_add_u32 s47, s45, 1024
    buffer_load_dwordx4 v2, s[36:39], s47 offen sc1 lds
    s_add_u32 s20, s67, 2
    s_cmp_ge_u32 s20, 24
    s_cselect_b32 s21, 24, 0
    s_sub_u32 s20, s20, s21
    s_lshl_b32 s45, s20, 11
    s_mul_i32 s46, s20, 10240
    s_add_u32 m0, s40, 36864
    s_nop 0
    buffer_load_dwordx4 v2, s[36:39], s45 offen sc1 lds
    s_add_u32 m0, s40, 40960
    s_add_u32 s47, s45, 1024
    buffer_load_dwordx4 v2, s[36:39], s47 offen sc1 lds
    s_add_u32 s20, s67, 3
    s_cmp_ge_u32 s20, 24
    s_cselect_b32 s21, 24, 0
    s_sub_u32 s20, s20, s21
    s_lshl_b32 s45, s20, 11
    s_mul_i32 s46, s20, 10240
    s_add_u32 m0, s40, 55296
    s_nop 0
    buffer_load_dwordx4 v2, s[36:39], s45 offen sc1 lds
    s_add_u32 m0, s40, 59392
    s_add_u32 s47, s45, 1024
    buffer_load_dwordx4 v2, s[36:39], s47 offen sc1 lds
    s_waitcnt vmcnt(6)
    s_barrier
    ds_read_b128 v[96:99], v6 offset:0
    ds_read_b128 v[100:103], v6 offset:1024
    ds_read_b64_tr_b16 v[104:105], v7 offset:0
    ds_read_b64_tr_b16 v[106:107], v7 offset:1280
    ds_read_b64_tr_b16 v[108:109], v7 offset:32
    ds_read_b64_tr_b16 v[110:111], v7 offset:1312
    ds_read_b64_tr_b16 v[112:113], v7 offset:64
    ds_read_b64_tr_b16 v[114:115], v7 offset:1344
    s_add_u32 s20, s67, 3
    s_cmp_ge_u32 s20, 24
    s_cselect_b32 s21, 24, 0
    s_sub_u32 s20, s20, s21
    s_lshl_b32 s45, s20, 11
    s_mul_i32 s46, s20, 10240
    s_waitcnt lgkmcnt(0)
    ds_read_b128 v[116:119], v6 offset:4096
    ds_read_b128 v[120:123], v6 offset:5120
    ds_read_b64_tr_b16 v[124:125], v7 offset:5120
    ds_read_b64_tr_b16 v[126:127], v7 offset:6400
    ds_read_b64_tr_b16 v[128:129], v7 offset:5152
    ds_read_b64_tr_b16 v[130:131], v7 offset:6432
    ds_read_b64_tr_b16 v[132:133], v7 offset:5184
    ds_read_b64_tr_b16 v[134:135], v7 offset:6464
    v_mfma_f32_16x16x32_bf16 v[64:67], v[104:107], v[96:99], v[64:67]
    v_mfma_f32_16x16x32_bf16 v[68:71], v[104:107], v[100:103], v[68:71]
    v_mfma_f32_16x16x32_bf16 v[72:75], v[108:111], v[96:99], v[72:75]
    v_mfma_f32_16x16x32_bf16 v[76:79], v[108:111], v[100:103], v[76:79]
    v_mfma_f32_16x16x32_bf16 v[80:83], v[112:115], v[96:99], v[80:83]
    v_mfma_f32_16x16x32_bf16 v[84:87], v[112:115], v[100:103], v[84:87]
    s_add_u32 s45, s45, 2048
    s_cmp_ge_u32 s45, s64
    s_cselect_b32 s21, s64, 0
    s_sub_u32 s45, s45, s21
    s_add_u32 s46, s46, 10240
    s_cmp_ge_u32 s46, s65
    s_cselect_b32 s21, s65, 0
    s_sub_u32 s46, s46, s21
    s_waitcnt vmcnt(4) lgkmcnt(0)
    s_barrier
    ds_read_b128 v[96:99], v6 offset:18432
    ds_read_b128 v[100:103], v6 offset:19456
    ds_read_b64_tr_b16 v[104:105], v7 offset:18432
    ds_read_b64_tr_b16 v[106:107], v7 offset:19712
    ds_read_b64_tr_b16 v[108:109], v7 offset:18464
    ds_read_b64_tr_b16 v[110:111], v7 offset:19744
    ds_read_b64_tr_b16 v[112:113], v7 offset:18496
    ds_read_b64_tr_b16 v[114:115], v7 offset:19776
    v_mfma_f32_16x16x32_bf16 v[64:67], v[124:127], v[116:119], v[64:67]
    s_add_u32 m0, s40, 0
    s_nop 0
    buffer_load_dwordx4 v2, s[36:39], s45 offen sc1 lds
    v_mfma_f32_16x16x32_bf16 v[68:71], v[124:127], v[120:123], v[68:71]
    v_mfma_f32_16x16x32_bf16 v[72:75], v[128:131], v[116:119], v[72:75]
    s_add_u32 m0, s40, 4096
    s_add_u32 s47, s45, 1024
    buffer_load_dwordx4 v2, s[36:39], s47 offen sc1 lds
    v_mfma_f32_16x16x32_bf16 v[76:79], v[128:131], v[120:123], v[76:79]
    v_mfma_f32_16x16x32_bf16 v[80:83], v[132:135], v[116:119], v[80:83]
    v_mfma_f32_16x16x32_bf16 v[84:87], v[132:135], v[120:123], v[84:87]
    s_waitcnt lgkmcnt(0)
    ds_read_b128 v[116:119], v6 offset:22528
    ds_read_b128 v[120:123], v6 offset:23552
    ds_read_b64_tr_b16 v[124:125], v7 offset:23552
    ds_read_b64_tr_b16 v[126:127], v7 offset:24832
    ds_read_b64_tr_b16 v[128:129], v7 offset:23584
    ds_read_b64_tr_b16 v[130:131], v7 offset:24864
    ds_read_b64_tr_b16 v[132:133], v7 offset:23616
    ds_read_b64_tr_b16 v[134:135], v7 offset:24896
    v_mfma_f32_16x16x32_bf16 v[64:67], v[104:107], v[96:99], v[64:67]
    v_mfma_f32_16x16x32_bf16 v[68:71], v[104:107], v[100:103], v[68:71]
    s_add_u32 m0, s41, 0
    s_nop 0
    buffer_load_dwordx4 v3, s[28:31], s46 offen offset:0 sc1 lds
    v_mfma_f32_16x16x32_bf16 v[72:75], v[108:111], v[96:99], v[72:75]
    v_mfma_f32_16x16x32_bf16 v[76:79], v[108:111], v[100:103], v[76:79]
    s_add_u32 m0, s41, 0
    s_nop 0
    buffer_load_dwordx4 v3, s[28:31], s46 offen offset:1024 sc1 lds
    v_mfma_f32_16x16x32_bf16 v[80:83], v[112:115], v[96:99], v[80:83]
    v_mfma_f32_16x16x32_bf16 v[84:87], v[112:115], v[100:103], v[84:87]
    s_add_u32 s45, s45, 2048
    s_cmp_ge_u32 s45, s64
    s_cselect_b32 s21, s64, 0
    s_sub_u32 s45, s45, s21
    s_add_u32 s46, s46, 10240
    s_cmp_ge_u32 s46, s65
    s_cselect_b32 s21, s65, 0
    s_sub_u32 s46, s46, s21
    s_waitcnt vmcnt(6) lgkmcnt(0)
    s_barrier
    ds_read_b128 v[96:99], v6 offset:36864
    ds_read_b128 v[100:103], v6 offset:37888
    ds_read_b64_tr_b16 v[104:105], v7 offset:36864
    ds_read_b64_tr_b16 v[106:107], v7 offset:38144
    ds_read_b64_tr_b16 v[108:109], v7 offset:36896
    ds_read_b64_tr_b16 v[110:111], v7 offset:38176
    ds_read_b64_tr_b16 v[112:113], v7 offset:36928
    ds_read_b64_tr_b16 v[114:115], v7 offset:38208
    v_mfma_f32_16x16x32_bf16 v[64:67], v[124:127], v[116:119], v[64:67]
    s_add_u32 m0, s40, 18432
    s_nop 0
    buffer_load_dwordx4 v2, s[36:39], s45 offen sc1 lds
    v_mfma_f32_16x16x32_bf16 v[68:71], v[124:127], v[120:123], v[68:71]
    v_mfma_f32_16x16x32_bf16 v[72:75], v[128:131], v[116:119], v[72:75]
    s_add_u32 m0, s40, 22528
    s_add_u32 s47, s45, 1024
    buffer_load_dwordx4 v2, s[36:39], s47 offen sc1 lds
    v_mfma_f32_16x16x32_bf16 v[76:79], v[128:131], v[120:123], v[76:79]
    v_mfma_f32_16x16x32_bf16 v[80:83], v[132:135], v[116:119], v[80:83]
    v_mfma_f32_16x16x32_bf16 v[84:87], v[132:135], v[120:123], v[84:87]
    s_waitcnt lgkmcnt(0)
    ds_read_b128 v[116:119], v6 offset:40960
    ds_read_b128 v[120:123], v6 offset:41984
    ds_read_b64_tr_b16 v[124:125], v7 offset:41984
    ds_read_b64_tr_b16 v[126:127], v7 offset:43264
    ds_read_b64_tr_b16 v[128:129], v7 offset:42016
    ds_read_b64_tr_b16 v[130:131], v7 offset:43296
    ds_read_b64_tr_b16 v[132:133], v7 offset:42048
    ds_read_b64_tr_b16 v[134:135], v7 offset:43328
    v_mfma_f32_16x16x32_bf16 v[64:67], v[104:107], v[96:99], v[64:67]
    v_mfma_f32_16x16x32_bf16 v[68:71], v[104:107], v[100:103], v[68:71]
    s_add_u32 m0, s41, 18432
    s_nop 0
    buffer_load_dwordx4 v3, s[28:31], s46 offen offset:0 sc1 lds
    v_mfma_f32_16x16x32_bf16 v[72:75], v[108:111], v[96:99], v[72:75]
    v_mfma_f32_16x16x32_bf16 v[76:79], v[108:111], v[100:103], v[76:79]
    s_add_u32 m0, s41, 18432
    s_nop 0
    buffer_load_dwordx4 v3, s[28:31], s46 offen offset:1024 sc1 lds
    v_mfma_f32_16x16x32_bf16 v[80:83], v[112:115], v[96:99], v[80:83]
    v_mfma_f32_16x16x32_bf16 v[84:87], v[112:115], v[100:103], v[84:87]
    s_add_u32 s45, s45, 2048
    s_cmp_ge_u32 s45, s64
    s_cselect_b32 s21, s64, 0
    s_sub_u32 s45, s45, s21
    s_add_u32 s46, s46, 10240
    s_cmp_ge_u32 s46, s65
    s_cselect_b32 s21, s65, 0
    s_sub_u32 s46, s46, s21
    s_waitcnt vmcnt(8) lgkmcnt(0)
    s_barrier
    ds_read_b128 v[96:99], v6 offset:55296
    ds_read_b128 v[100:103], v6 offset:56320
    ds_read_b64_tr_b16 v[104:105], v7 offset:55296
    ds_read_b64_tr_b16 v[106:107], v7 offset:56576
    ds_read_b64_tr_b16 v[108:109], v7 offset:55328
    ds_read_b64_tr_b16 v[110:111], v7 offset:56608
    ds_read_b64_tr_b16 v[112:113], v7 offset:55360
    ds_read_b64_tr_b16 v[114:115], v7 offset:56640
    v_mfma_f32_16x16x32_bf16 v[64:67], v[124:127], v[116:119], v[64:67]
    s_add_u32 m0, s40, 36864
    s_nop 0
    buffer_load_dwordx4 v2, s[36:39], s45 offen sc1 lds
    v_mfma_f32_16x16x32_bf16 v[68:71], v[124:127], v[120:123], v[68:71]
    v_mfma_f32_16x16x32_bf16 v[72:75], v[128:131], v[116:119], v[72:75]
    s_add_u32 m0, s40, 40960
    s_add_u32 s47, s45, 1024
    buffer_load_dwordx4 v2, s[36:39], s47 offen sc1 lds
    v_mfma_f32_16x16x32_bf16 v[76:79], v[128:131], v[120:123], v[76:79]
    v_mfma_f32_16x16x32_bf16 v[80:83], v[132:135], v[116:119], v[80:83]
    v_mfma_f32_16x16x32_bf16 v[84:87], v[132:135], v[120:123], v[84:87]
    s_waitcnt lgkmcnt(0)
    ds_read_b128 v[116:119], v6 offset:59392
    ds_read_b128 v[120:123], v6 offset:60416
    ds_read_b64_tr_b16 v[124:125], v7 offset:60416
    ds_read_b64_tr_b16 v[126:127], v7 offset:61696
    ds_read_b64_tr_b16 v[128:129], v7 offset:60448
    ds_read_b64_tr_b16 v[130:131], v7 offset:61728
    ds_read_b64_tr_b16 v[132:133], v7 offset:60480
    ds_read_b64_tr_b16 v[134:135], v7 offset:61760
    v_mfma_f32_16x16x32_bf16 v[64:67], v[104:107], v[96:99], v[64:67]
    v_mfma_f32_16x16x32_bf16 v[68:71], v[104:107], v[100:103], v[68:71]
    s_add_u32 m0, s41, 36864
    s_nop 0
    buffer_load_dwordx4 v3, s[28:31], s46 offen offset:0 sc1 lds
    v_mfma_f32_16x16x32_bf16 v[72:75], v[108:111], v[96:99], v[72:75]
    v_mfma_f32_16x16x32_bf16 v[76:79], v[108:111], v[100:103], v[76:79]
    s_add_u32 m0, s41, 36864
    s_nop 0
    buffer_load_dwordx4 v3, s[28:31], s46 offen offset:1024 sc1 lds
    v_mfma_f32_16x16x32_bf16 v[80:83], v[112:115], v[96:99], v[80:83]
    v_mfma_f32_16x16x32_bf16 v[84:87], v[112:115], v[100:103], v[84:87]
    s_add_u32 s45, s45, 2048
    s_cmp_ge_u32 s45, s64
    s_cselect_b32 s21, s64, 0
    s_sub_u32 s45, s45, s21
    s_add_u32 s46, s46, 10240
    s_cmp_ge_u32 s46, s65
    s_cselect_b32 s21, s65, 0
    s_sub_u32 s46, s46, s21
    s_waitcnt vmcnt(8) lgkmcnt(0)
    s_barrier
    ds_read_b128 v[96:99], v6 offset:0
    ds_read_b128 v[100:103], v6 offset:1024
    ds_read_b64_tr_b16 v[104:105], v7 offset:0
    ds_read_b64_tr_b16 v[106:107], v7 offset:1280
    ds_read_b64_tr_b16 v[108:109], v7 offset:32
    ds_read_b64_tr_b16 v[110:111], v7 offset:1312
    ds_read_b64_tr_b16 v[112:113], v7 offset:64
    ds_read_b64_tr_b16 v[114:115], v7 offset:1344
    v_mfma_f32_16x16x32_bf16 v[64:67], v[124:127], v[116:119], v[64:67]
    s_add_u32 m0, s40, 55296
    s_nop 0
    buffer_load_dwordx4 v2, s[36:39], s45 offen sc1 lds
    v_mfma_f32_16x16x32_bf16 v[68:71], v[124:127], v[120:123], v[68:71]
    v_mfma_f32_16x16x32_bf16 v[72:75], v[128:131], v[116:119], v[72:75]
    s_add_u32 m0, s40, 59392
    s_add_u32 s47, s45, 1024
    buffer_load_dwordx4 v2, s[36:39], s47 offen sc1 lds
    v_mfma_f32_16x16x32_bf16 v[76:79], v[128:131], v[120:123], v[76:79]
    v_mfma_f32_16x16x32_bf16 v[80:83], v[132:135], v[116:119], v[80:83]
    v_mfma_f32_16x16x32_bf16 v[84:87], v[132:135], v[120:123], v[84:87]
    s_mov_b32 s63, 4
g_2a_loop:
    s_waitcnt lgkmcnt(0)
    ds_read_b128 v[116:119], v6 offset:4096
    ds_read_b128 v[120:123], v6 offset:5120
    ds_read_b64_tr_b16 v[124:125], v7 offset:5120
    ds_read_b64_tr_b16 v[126:127], v7 offset:6400
    ds_read_b64_tr_b16 v[128:129], v7 offset:5152
    ds_read_b64_tr_b16 v[130:131], v7 offset:6432
    ds_read_b64_tr_b16 v[132:133], v7 offset:5184
    ds_read_b64_tr_b16 v[134:135], v7 offset:6464
    v_mfma_f32_16x16x32_bf16 v[64:67], v[104:107], v[96:99], v[64:67]
    v_mfma_f32_16x16x32_bf16 v[68:71], v[104:107], v[100:103], v[68:71]
    s_add_u32 m0, s41, 55296
    s_nop 0
    buffer_load_dwordx4 v3, s[28:31], s46 offen offset:0 sc1 lds
    v_mfma_f32_16x16x32_bf16 v[72:75], v[108:111], v[96:99], v[72:75]
    v_mfma_f32_16x16x32_bf16 v[76:79], v[108:111], v[100:103], v[76:79]
    s_add_u32 m0, s41, 55296
    s_nop 0
    buffer_load_dwordx4 v3, s[28:31], s46 offen offset:1024 sc1 lds
    v_mfma_f32_16x16x32_bf16 v[80:83], v[112:115], v[96:99], v[80:83]
    v_mfma_f32_16x16x32_bf16 v[84:87], v[112:115], v[100:103], v[84:87]
    s_add_u32 s45, s45, 2048
    s_cmp_ge_u32 s45, s64
    s_cselect_b32 s21, s64, 0
    s_sub_u32 s45, s45, s21
    s_add_u32 s46, s46, 10240
    s_cmp_ge_u32 s46, s65
    s_cselect_b32 s21, s65, 0
    s_sub_u32 s46, s46, s21
    s_waitcnt vmcnt(8) lgkmcnt(0)
    s_barrier
    ds_read_b128 v[96:99], v6 offset:18432
    ds_read_b128 v[100:103], v6 offset:19456
    ds_read_b64_tr_b16 v[104:105], v7 offset:18432
    ds_read_b64_tr_b16 v[106:107], v7 offset:19712
    ds_read_b64_tr_b16 v[108:109], v7 offset:18464
    ds_read_b64_tr_b16 v[110:111], v7 offset:19744
    ds_read_b64_tr_b16 v[112:113], v7 offset:18496
    ds_read_b64_tr_b16 v[114:115], v7 offset:19776
    v_mfma_f32_16x16x32_bf16 v[64:67], v[124:127], v[116:119], v[64:67]
    s_add_u32 m0, s40, 0
    s_nop 0
    buffer_load_dwordx4 v2, s[36:39], s45 offen sc1 lds
    v_mfma_f32_16x16x32_bf16 v[68:71], v[124:127], v[120:123], v[68:71]
    v_mfma_f32_16x16x32_bf16 v[72:75], v[128:131], v[116:119], v[72:75]
    s_add_u32 m0, s40, 4096
    s_add_u32 s47, s45, 1024
    buffer_load_dwordx4 v2, s[36:39], s47 offen sc1 lds
    v_mfma_f32_16x16x32_bf16 v[76:79], v[128:131], v[120:123], v[76:79]
    v_mfma_f32_16x16x32_bf16 v[80:83], v[132:135], v[116:119], v[80:83]
    v_mfma_f32_16x16x32_bf16 v[84:87], v[132:135], v[120:123], v[84:87]
    s_waitcnt lgkmcnt(0)
    ds_read_b128 v[116:119], v6 offset:22528
    ds_read_b128 v[120:123], v6 offset:23552
    ds_read_b64_tr_b16 v[124:125], v7 offset:23552
    ds_read_b64_tr_b16 v[126:127], v7 offset:24832
    ds_read_b64_tr_b16 v[128:129], v7 offset:23584
    ds_read_b64_tr_b16 v[130:131], v7 offset:24864
    ds_read_b64_tr_b16 v[132:133], v7 offset:23616
    ds_read_b64_tr_b16 v[134:135], v7 offset:24896
    v_mfma_f32_16x16x32_bf16 v[64:67], v[104:107], v[96:99], v[64:67]
    v_mfma_f32_16x16x32_bf16 v[68:71], v[104:107], v[100:103], v[68:71]
    s_add_u32 m0, s41, 0
    s_nop 0
    buffer_load_dwordx4 v3, s[28:31], s46 offen offset:0 sc1 lds
    v_mfma_f32_16x16x32_bf16 v[72:75], v[108:111], v[96:99], v[72:75]
    v_mfma_f32_16x16x32_bf16 v[76:79], v[108:111], v[100:103], v[76:79]
    s_add_u32 m0, s41, 0
    s_nop 0
    buffer_load_dwordx4 v3, s[28:31], s46 offen offset:1024 sc1 lds
    v_mfma_f32_16x16x32_bf16 v[80:83], v[112:115], v[96:99], v[80:83]
    v_mfma_f32_16x16x32_bf16 v[84:87], v[112:115], v[100:103], v[84:87]
    s_add_u32 s45, s45, 2048
    s_cmp_ge_u32 s45, s64
    s_cselect_b32 s21, s64, 0
    s_sub_u32 s45, s45, s21
    s_add_u32 s46, s46, 10240
    s_cmp_ge_u32 s46, s65
    s_cselect_b32 s21, s65, 0
    s_sub_u32 s46, s46, s21
    s_waitcnt vmcnt(8) lgkmcnt(0)
    s_barrier
    ds_read_b128 v[96:99], v6 offset:36864
    ds_read_b128 v[100:103], v6 offset:37888
    ds_read_b64_tr_b16 v[104:105], v7 offset:36864
    ds_read_b64_tr_b16 v[106:107], v7 offset:38144
    ds_read_b64_tr_b16 v[108:109], v7 offset:36896
    ds_read_b64_tr_b16 v[110:111], v7 offset:38176
    ds_read_b64_tr_b16 v[112:113], v7 offset:36928
    ds_read_b64_tr_b16 v[114:115], v7 offset:38208
    v_mfma_f32_16x16x32_bf16 v[64:67], v[124:127], v[116:119], v[64:67]
    s_add_u32 m0, s40, 18432
    s_nop 0
    buffer_load_dwordx4 v2, s[36:39], s45 offen sc1 lds
    v_mfma_f32_16x16x32_bf16 v[68:71], v[124:127], v[120:123], v[68:71]
    v_mfma_f32_16x16x32_bf16 v[72:75], v[128:131], v[116:119], v[72:75]
    s_add_u32 m0, s40, 22528
    s_add_u32 s47, s45, 1024
    buffer_load_dwordx4 v2, s[36:39], s47 offen sc1 lds
    v_mfma_f32_16x16x32_bf16 v[76:79], v[128:131], v[120:123], v[76:79]
    v_mfma_f32_16x16x32_bf16 v[80:83], v[132:135], v[116:119], v[80:83]
    v_mfma_f32_16x16x32_bf16 v[84:87], v[132:135], v[120:123], v[84:87]
    s_waitcnt lgkmcnt(0)
    ds_read_b128 v[116:119], v6 offset:40960
    ds_read_b128 v[120:123], v6 offset:41984
    ds_read_b64_tr_b16 v[124:125], v7 offset:41984
    ds_read_b64_tr_b16 v[126:127], v7 offset:43264
    ds_read_b64_tr_b16 v[128:129], v7 offset:42016
    ds_read_b64_tr_b16 v[130:131], v7 offset:43296
    ds_read_b64_tr_b16 v[132:133], v7 offset:42048
    ds_read_b64_tr_b16 v[134:135], v7 offset:43328
    v_mfma_f32_16x16x32_bf16 v[64:67], v[104:107], v[96:99], v[64:67]
    v_mfma_f32_16x16x32_bf16 v[68:71], v[104:107], v[100:103], v[68:71]
    s_add_u32 m0, s41, 18432
    s_nop 0
    buffer_load_dwordx4 v3, s[28:31], s46 offen offset:0 sc1 lds
    v_mfma_f32_16x16x32_bf16 v[72:75], v[108:111], v[96:99], v[72:75]
    v_mfma_f32_16x16x32_bf16 v[76:79], v[108:111], v[100:103], v[76:79]
    s_add_u32 m0, s41, 18432
    s_nop 0
    buffer_load_dwordx4 v3, s[28:31], s46 offen offset:1024 sc1 lds
    v_mfma_f32_16x16x32_bf16 v[80:83], v[112:115], v[96:99], v[80:83]
    v_mfma_f32_16x16x32_bf16 v[84:87], v[112:115], v[100:103], v[84:87]
    s_add_u32 s45, s45, 2048
    s_cmp_ge_u32 s45, s64
    s_cselect_b32 s21, s64, 0
    s_sub_u32 s45, s45, s21
    s_add_u32 s46, s46, 10240
    s_cmp_ge_u32 s46, s65
    s_cselect_b32 s21, s65, 0
    s_sub_u32 s46, s46, s21
    s_waitcnt vmcnt(8) lgkmcnt(0)
    s_barrier
    ds_read_b128 v[96:99], v6 offset:55296
    ds_read_b128 v[100:103], v6 offset:56320
    ds_read_b64_tr_b16 v[104:105], v7 offset:55296
    ds_read_b64_tr_b16 v[106:107], v7 offset:56576
    ds_read_b64_tr_b16 v[108:109], v7 offset:55328
    ds_read_b64_tr_b16 v[110:111], v7 offset:56608
    ds_read_b64_tr_b16 v[112:113], v7 offset:55360
    ds_read_b64_tr_b16 v[114:115], v7 offset:56640
    v_mfma_f32_16x16x32_bf16 v[64:67], v[124:127], v[116:119], v[64:67]
    s_add_u32 m0, s40, 36864
    s_nop 0
    buffer_load_dwordx4 v2, s[36:39], s45 offen sc1 lds
    v_mfma_f32_16x16x32_bf16 v[68:71], v[124:127], v[120:123], v[68:71]
    v_mfma_f32_16x16x32_bf16 v[72:75], v[128:131], v[116:119], v[72:75]
    s_add_u32 m0, s40, 40960
    s_add_u32 s47, s45, 1024
    buffer_load_dwordx4 v2, s[36:39], s47 offen sc1 lds
    v_mfma_f32_16x16x32_bf16 v[76:79], v[128:131], v[120:123], v[76:79]
    v_mfma_f32_16x16x32_bf16 v[80:83], v[132:135], v[116:119], v[80:83]
    v_mfma_f32_16x16x32_bf16 v[84:87], v[132:135], v[120:123], v[84:87]
    s_waitcnt lgkmcnt(0)
    ds_read_b128 v[116:119], v6 offset:59392
    ds_read_b128 v[120:123], v6 offset:60416
    ds_read_b64_tr_b16 v[124:125], v7 offset:60416
    ds_read_b64_tr_b16 v[126:127], v7 offset:61696
    ds_read_b64_tr_b16 v[128:129], v7 offset:60448
    ds_read_b64_tr_b16 v[130:131], v7 offset:61728
    ds_read_b64_tr_b16 v[132:133], v7 offset:60480
    ds_read_b64_tr_b16 v[134:135], v7 offset:61760
    v_mfma_f32_16x16x32_bf16 v[64:67], v[104:107], v[96:99], v[64:67]
    v_mfma_f32_16x16x32_bf16 v[68:71], v[104:107], v[100:103], v[68:71]
    s_add_u32 m0, s41, 36864
    s_nop 0
    buffer_load_dwordx4 v3, s[28:31], s46 offen offset:0 sc1 lds
    v_mfma_f32_16x16x32_bf16 v[72:75], v[108:111], v[96:99], v[72:75]
    v_mfma_f32_16x16x32_bf16 v[76:79], v[108:111], v[100:103], v[76:79]
    s_add_u32 m0, s41, 36864
    s_nop 0
    buffer_load_dwordx4 v3, s[28:31], s46 offen offset:1024 sc1 lds
    v_mfma_f32_16x16x32_bf16 v[80:83], v[112:115], v[96:99], v[80:83]
    v_mfma_f32_16x16x32_bf16 v[84:87], v[112:115], v[100:103], v[84:87]
    s_add_u32 s45, s45, 2048
    s_cmp_ge_u32 s45, s64
    s_cselect_b32 s21, s64, 0
    s_sub_u32 s45, s45, s21
    s_add_u32 s46, s46, 10240
    s_cmp_ge_u32 s46, s65
    s_cselect_b32 s21, s65, 0
    s_sub_u32 s46, s46, s21
    s_waitcnt vmcnt(8) lgkmcnt(0)
    s_barrier
    ds_read_b128 v[96:99], v6 offset:0
    ds_read_b128 v[100:103], v6 offset:1024
    ds_read_b64_tr_b16 v[104:105], v7 offset:0
    ds_read_b64_tr_b16 v[106:107], v7 offset:1280
    ds_read_b64_tr_b16 v[108:109], v7 offset:32
    ds_read_b64_tr_b16 v[110:111], v7 offset:1312
    ds_read_b64_tr_b16 v[112:113], v7 offset:64
    ds_read_b64_tr_b16 v[114:115], v7 offset:1344
    v_mfma_f32_16x16x32_bf16 v[64:67], v[124:127], v[116:119], v[64:67]
    s_add_u32 m0, s40, 55296
    s_nop 0
    buffer_load_dwordx4 v2, s[36:39], s45 offen sc1 lds
    v_mfma_f32_16x16x32_bf16 v[68:71], v[124:127], v[120:123], v[68:71]
    v_mfma_f32_16x16x32_bf16 v[72:75], v[128:131], v[116:119], v[72:75]
    s_add_u32 m0, s40, 59392
    s_add_u32 s47, s45, 1024
    buffer_load_dwordx4 v2, s[36:39], s47 offen sc1 lds
    v_mfma_f32_16x16x32_bf16 v[76:79], v[128:131], v[120:123], v[76:79]
    v_mfma_f32_16x16x32_bf16 v[80:83], v[132:135], v[116:119], v[80:83]
    v_mfma_f32_16x16x32_bf16 v[84:87], v[132:135], v[120:123], v[84:87]
    s_sub_u32 s63, s63, 1
    s_cmp_lg_u32 s63, 0
    s_cbranch_scc1 g_2a_loop
    s_waitcnt lgkmcnt(0)
    ds_read_b128 v[116:119], v6 offset:4096
    ds_read_b128 v[120:123], v6 offset:5120
    ds_read_b64_tr_b16 v[124:125], v7 offset:5120
    ds_read_b64_tr_b16 v[126:127], v7 offset:6400
    ds_read_b64_tr_b16 v[128:129], v7 offset:5152
    ds_read_b64_tr_b16 v[130:131], v7 offset:6432
    ds_read_b64_tr_b16 v[132:133], v7 offset:5184
    ds_read_b64_tr_b16 v[134:135], v7 offset:6464
    v_mfma_f32_16x16x32_bf16 v[64:67], v[104:107], v[96:99], v[64:67]
    v_mfma_f32_16x16x32_bf16 v[68:71], v[104:107], v[100:103], v[68:71]
    s_add_u32 m0, s41, 55296
    s_nop 0
    buffer_load_dwordx4 v3, s[28:31], s46 offen offset:0 sc1 lds
    v_mfma_f32_16x16x32_bf16 v[72:75], v[108:111], v[96:99], v[72:75]
    v_mfma_f32_16x16x32_bf16 v[76:79], v[108:111], v[100:103], v[76:79]
    s_add_u32 m0, s41, 55296
    s_nop 0
    buffer_load_dwordx4 v3, s[28:31], s46 offen offset:1024 sc1 lds
    v_mfma_f32_16x16x32_bf16 v[80:83], v[112:115], v[96:99], v[80:83]
    v_mfma_f32_16x16x32_bf16 v[84:87], v[112:115], v[100:103], v[84:87]
    s_add_u32 s45, s45, 2048
    s_cmp_ge_u32 s45, s64
    s_cselect_b32 s21, s64, 0
    s_sub_u32 s45, s45, s21
    s_add_u32 s46, s46, 10240
    s_cmp_ge_u32 s46, s65
    s_cselect_b32 s21, s65, 0
    s_sub_u32 s46, s46, s21
    s_waitcnt vmcnt(8) lgkmcnt(0)
    s_barrier
    ds_read_b128 v[96:99], v6 offset:18432
    ds_read_b128 v[100:103], v6 offset:19456
    ds_read_b64_tr_b16 v[104:105], v7 offset:18432
    ds_read_b64_tr_b16 v[106:107], v7 offset:19712
    ds_read_b64_tr_b16 v[108:109], v7 offset:18464
    ds_read_b64_tr_b16 v[110:111], v7 offset:19744
    ds_read_b64_tr_b16 v[112:113], v7 offset:18496
    ds_read_b64_tr_b16 v[114:115], v7 offset:19776
    s_mov_b32 s20, 65536
    buffer_load_dword v17, v11, s[72:75], s20 offen sc1
    v_mfma_f32_16x16x32_bf16 v[64:67], v[124:127], v[116:119], v[64:67]
    v_mfma_f32_16x16x32_bf16 v[68:71], v[124:127], v[120:123], v[68:71]
    v_mfma_f32_16x16x32_bf16 v[72:75], v[128:131], v[116:119], v[72:75]
    v_mfma_f32_16x16x32_bf16 v[76:79], v[128:131], v[120:123], v[76:79]
    v_mfma_f32_16x16x32_bf16 v[80:83], v[132:135], v[116:119], v[80:83]
    v_mfma_f32_16x16x32_bf16 v[84:87], v[132:135], v[120:123], v[84:87]
    s_waitcnt lgkmcnt(0)
    ds_read_b128 v[116:119], v6 offset:22528
    ds_read_b128 v[120:123], v6 offset:23552
    ds_read_b64_tr_b16 v[124:125], v7 offset:23552
    ds_read_b64_tr_b16 v[126:127], v7 offset:24832
    ds_read_b64_tr_b16 v[128:129], v7 offset:23584
    ds_read_b64_tr_b16 v[130:131], v7 offset:24864
    ds_read_b64_tr_b16 v[132:133], v7 offset:23616
    ds_read_b64_tr_b16 v[134:135], v7 offset:24896
    v_mfma_f32_16x16x32_bf16 v[64:67], v[104:107], v[96:99], v[64:67]
    v_mfma_f32_16x16x32_bf16 v[68:71], v[104:107], v[100:103], v[68:71]
    v_mfma_f32_16x16x32_bf16 v[72:75], v[108:111], v[96:99], v[72:75]
    v_mfma_f32_16x16x32_bf16 v[76:79], v[108:111], v[100:103], v[76:79]
    v_mfma_f32_16x16x32_bf16 v[80:83], v[112:115], v[96:99], v[80:83]
    v_mfma_f32_16x16x32_bf16 v[84:87], v[112:115], v[100:103], v[84:87]
    s_waitcnt vmcnt(5) lgkmcnt(0)
    s_barrier
    ds_read_b128 v[96:99], v6 offset:36864
    ds_read_b128 v[100:103], v6 offset:37888
    ds_read_b64_tr_b16 v[104:105], v7 offset:36864
    ds_read_b64_tr_b16 v[106:107], v7 offset:38144
    ds_read_b64_tr_b16 v[108:109], v7 offset:36896
    ds_read_b64_tr_b16 v[110:111], v7 offset:38176
    ds_read_b64_tr_b16 v[112:113], v7 offset:36928
    ds_read_b64_tr_b16 v[114:115], v7 offset:38208
    v_mfma_f32_16x16x32_bf16 v[64:67], v[124:127], v[116:119], v[64:67]
    v_mfma_f32_16x16x32_bf16 v[68:71], v[124:127], v[120:123], v[68:71]
    v_mfma_f32_16x16x32_bf16 v[72:75], v[128:131], v[116:119], v[72:75]
    v_mfma_f32_16x16x32_bf16 v[76:79], v[128:131], v[120:123], v[76:79]
    v_mfma_f32_16x16x32_bf16 v[80:83], v[132:135], v[116:119], v[80:83]
    v_mfma_f32_16x16x32_bf16 v[84:87], v[132:135], v[120:123], v[84:87]
    s_waitcnt lgkmcnt(0)
    ds_read_b128 v[116:119], v6 offset:40960
    ds_read_b128 v[120:123], v6 offset:41984
    ds_read_b64_tr_b16 v[124:125], v7 offset:41984
    ds_read_b64_tr_b16 v[126:127], v7 offset:43264
    ds_read_b64_tr_b16 v[128:129], v7 offset:42016
    ds_read_b64_tr_b16 v[130:131], v7 offset:43296
    ds_read_b64_tr_b16 v[132:133], v7 offset:42048
    ds_read_b64_tr_b16 v[134:135], v7 offset:43328
    v_mfma_f32_16x16x32_bf16 v[64:67], v[104:107], v[96:99], v[64:67]
    v_mfma_f32_16x16x32_bf16 v[68:71], v[104:107], v[100:103], v[68:71]
    v_mfma_f32_16x16x32_bf16 v[72:75], v[108:111], v[96:99], v[72:75]
    v_mfma_f32_16x16x32_bf16 v[76:79], v[108:111], v[100:103], v[76:79]
    v_mfma_f32_16x16x32_bf16 v[80:83], v[112:115], v[96:99], v[80:83]
    v_mfma_f32_16x16x32_bf16 v[84:87], v[112:115], v[100:103], v[84:87]
    s_waitcnt vmcnt(0) lgkmcnt(0)
    s_barrier
    ds_read_b128 v[96:99], v6 offset:55296
    ds_read_b128 v[100:103], v6 offset:56320
    ds_read_b64_tr_b16 v[104:105], v7 offset:55296
    ds_read_b64_tr_b16 v[106:107], v7 offset:56576
    ds_read_b64_tr_b16 v[108:109], v7 offset:55328
    ds_read_b64_tr_b16 v[110:111], v7 offset:56608
    ds_read_b64_tr_b16 v[112:113], v7 offset:55360
    ds_read_b64_tr_b16 v[114:115], v7 offset:56640
    v_cmp_ne_u32 vcc, s70, v17
    s_nop 4
    s_cbranch_vccz g_2a_yok
    s_mov_b32 s20, 4096
    s_mov_b32 s21, 65536
g_2a_py_pl:
    buffer_load_dword v17, v11, s[72:75], s21 offen sc1
    s_waitcnt vmcnt(0)
    v_xor_b32 v17, s70, v17
    v_cmp_ne_u32 vcc, 0, v17
    s_sub_u32 s20, s20, 1
    s_cmp_eq_u32 s20, 0
    s_cbranch_scc1 g_2a_py_pd
    s_nop 1
    s_cbranch_vccz g_2a_py_pd
    s_sleep 4
    s_branch g_2a_py_pl
g_2a_py_pd:
g_2a_yok:
    s_lshl_b32 s21, s60, 7
    s_lshl_b32 s22, s43, 6
    s_add_u32 s21, s21, s22
    s_mul_i32 s22, s62, 3072
    s_add_u32 m0, s22, 0
    s_add_u32 s23, s21, 0
    buffer_load_dwordx4 v10, s[52:55], s23 offen sc1 lds
    s_add_u32 m0, s22, 1024
    s_add_u32 s23, s21, 67584
    buffer_load_dwordx4 v10, s[52:55], s23 offen sc1 lds
    s_add_u32 m0, s22, 2048
    s_add_u32 s23, s21, 135168
    buffer_load_dwordx4 v10, s[52:55], s23 offen sc1 lds
    v_mfma_f32_16x16x32_bf16 v[64:67], v[124:127], v[116:119], v[64:67]
    v_mfma_f32_16x16x32_bf16 v[68:71], v[124:127], v[120:123], v[68:71]
    v_mfma_f32_16x16x32_bf16 v[72:75], v[128:131], v[116:119], v[72:75]
    v_mfma_f32_16x16x32_bf16 v[76:79], v[128:131], v[120:123], v[76:79]
    v_mfma_f32_16x16x32_bf16 v[80:83], v[132:135], v[116:119], v[80:83]
    v_mfma_f32_16x16x32_bf16 v[84:87], v[132:135], v[120:123], v[84:87]
    s_waitcnt lgkmcnt(0)
    ds_read_b128 v[116:119], v6 offset:59392
    ds_read_b128 v[120:123], v6 offset:60416
    ds_read_b64_tr_b16 v[124:125], v7 offset:60416
    ds_read_b64_tr_b16 v[126:127], v7 offset:61696
    ds_read_b64_tr_b16 v[128:129], v7 offset:60448
    ds_read_b64_tr_b16 v[130:131], v7 offset:61728
    ds_read_b64_tr_b16 v[132:133], v7 offset:60480
    ds_read_b64_tr_b16 v[134:135], v7 offset:61760
    v_mfma_f32_16x16x32_bf16 v[64:67], v[104:107], v[96:99], v[64:67]
    v_mfma_f32_16x16x32_bf16 v[68:71], v[104:107], v[100:103], v[68:71]
    v_mfma_f32_16x16x32_bf16 v[72:75], v[108:111], v[96:99], v[72:75]
    v_mfma_f32_16x16x32_bf16 v[76:79], v[108:111], v[100:103], v[76:79]
    v_mfma_f32_16x16x32_bf16 v[80:83], v[112:115], v[96:99], v[80:83]
    v_mfma_f32_16x16x32_bf16 v[84:87], v[112:115], v[100:103], v[84:87]
    s_waitcnt lgkmcnt(0)
    v_mfma_f32_16x16x32_bf16 v[64:67], v[124:127], v[116:119], v[64:67]
    v_mfma_f32_16x16x32_bf16 v[68:71], v[124:127], v[120:123], v[68:71]
    v_mfma_f32_16x16x32_bf16 v[72:75], v[128:131], v[116:119], v[72:75]
    v_mfma_f32_16x16x32_bf16 v[76:79], v[128:131], v[120:123], v[76:79]
    v_mfma_f32_16x16x32_bf16 v[80:83], v[132:135], v[116:119], v[80:83]
    v_mfma_f32_16x16x32_bf16 v[84:87], v[132:135], v[120:123], v[84:87]
    v_lshrrev_b32 v16, 2, v1
    v_lshlrev_b32 v16, 6, v16
    v_and_b32 v17, 3, v1
    v_lshl_add_u32 v16, v17, 3, v16
    s_mul_i32 s22, s62, 3072
    v_add_u32 v16, s22, v16
    v_and_b32 v169, 0xffff0000, v168
    v_rcp_f32 v169, v169
    v_lshlrev_b32 v168, 16, v168
    v_mul_f32 v168, v168, v169
    v_sub_f32 v168, 0, v168
    v_and_b32 v171, 0xffff0000, v170
    v_rcp_f32 v171, v171
    v_lshlrev_b32 v170, 16, v170
    v_mul_f32 v170, v170, v171
    v_sub_f32 v170, 0, v170
    v_lshlrev_b32 v200, 16, v160
    v_and_b32 v201, 0xffff0000, v160
    v_lshlrev_b32 v202, 16, v161
    v_and_b32 v203, 0xffff0000, v161
    v_lshlrev_b32 v204, 16, v162
    v_and_b32 v205, 0xffff0000, v162
    v_lshlrev_b32 v206, 16, v163
    v_and_b32 v207, 0xffff0000, v163
    v_lshlrev_b32 v208, 16, v164
    v_and_b32 v209, 0xffff0000, v164
    v_lshlrev_b32 v210, 16, v165
    v_and_b32 v211, 0xffff0000, v165
    s_waitcnt vmcnt(0)
    ds_read_b64_tr_b16 v[176:177], v16 offset:0
    ds_read_b64_tr_b16 v[178:179], v16 offset:32
    ds_read_b64_tr_b16 v[180:181], v16 offset:1024
    ds_read_b64_tr_b16 v[182:183], v16 offset:1056
    ds_read_b64_tr_b16 v[184:185], v16 offset:2048
    ds_read_b64_tr_b16 v[186:187], v16 offset:2080
    s_waitcnt lgkmcnt(5)
    v_lshlrev_b32 v8, 16, v136
    v_and_b32 v9, 0xffff0000, v136
    v_add_f32 v64, v64, v8
    v_add_f32 v65, v65, v9
    v_fma_f32 v8, v8, v169, v168
    v_fma_f32 v9, v9, v169, v168
    v_lshlrev_b32 v12, 16, v176
    v_and_b32 v13, 0xffff0000, v176
    v_fmac_f32 v12, v8, v200
    v_fmac_f32 v13, v9, v201
    v_add_f32 v12, v12, v64
    v_add_f32 v13, v13, v65
    v_cvt_pk_bf16_f32 v136, v12, v13
    v_lshlrev_b32 v8, 16, v137
    v_and_b32 v9, 0xffff0000, v137
    v_add_f32 v66, v66, v8
    v_add_f32 v67, v67, v9
    v_fma_f32 v8, v8, v169, v168
    v_fma_f32 v9, v9, v169, v168
    v_lshlrev_b32 v12, 16, v177
    v_and_b32 v13, 0xffff0000, v177
    v_fmac_f32 v12, v8, v202
    v_fmac_f32 v13, v9, v203
    v_add_f32 v12, v12, v66
    v_add_f32 v13, v13, v67
    v_cvt_pk_bf16_f32 v137, v12, v13
    s_mov_b32 s23, 0
    buffer_store_dwordx2 v[136:137], v14, s[32:35], s23 offen offset:0
    s_waitcnt lgkmcnt(4)
    v_lshlrev_b32 v8, 16, v138
    v_and_b32 v9, 0xffff0000, v138
    v_add_f32 v68, v68, v8
    v_add_f32 v69, v69, v9
    v_fma_f32 v8, v8, v171, v170
    v_fma_f32 v9, v9, v171, v170
    v_lshlrev_b32 v12, 16, v178
    v_and_b32 v13, 0xffff0000, v178
    v_fmac_f32 v12, v8, v200
    v_fmac_f32 v13, v9, v201
    v_add_f32 v12, v12, v68
    v_add_f32 v13, v13, v69
    v_cvt_pk_bf16_f32 v138, v12, v13
    v_lshlrev_b32 v8, 16, v139
    v_and_b32 v9, 0xffff0000, v139
    v_add_f32 v70, v70, v8
    v_add_f32 v71, v71, v9
    v_fma_f32 v8, v8, v171, v170
    v_fma_f32 v9, v9, v171, v170
    v_lshlrev_b32 v12, 16, v179
    v_and_b32 v13, 0xffff0000, v179
    v_fmac_f32 v12, v8, v202
    v_fmac_f32 v13, v9, v203
    v_add_f32 v12, v12, v70
    v_add_f32 v13, v13, v71
    v_cvt_pk_bf16_f32 v139, v12, v13
    s_mov_b32 s23, 20480
    buffer_store_dwordx2 v[138:139], v14, s[32:35], s23 offen offset:0
    s_waitcnt lgkmcnt(3)
    v_lshlrev_b32 v8, 16, v140
    v_and_b32 v9, 0xffff0000, v140
    v_add_f32 v72, v72, v8
    v_add_f32 v73, v73, v9
    v_fma_f32 v8, v8, v169, v168
    v_fma_f32 v9, v9, v169, v168
    v_lshlrev_b32 v12, 16, v180
    v_and_b32 v13, 0xffff0000, v180
    v_fmac_f32 v12, v8, v204
    v_fmac_f32 v13, v9, v205
    v_add_f32 v12, v12, v72
    v_add_f32 v13, v13, v73
    v_cvt_pk_bf16_f32 v140, v12, v13
    v_lshlrev_b32 v8, 16, v141
    v_and_b32 v9, 0xffff0000, v141
    v_add_f32 v74, v74, v8
    v_add_f32 v75, v75, v9
    v_fma_f32 v8, v8, v169, v168
    v_fma_f32 v9, v9, v169, v168
    v_lshlrev_b32 v12, 16, v181
    v_and_b32 v13, 0xffff0000, v181
    v_fmac_f32 v12, v8, v206
    v_fmac_f32 v13, v9, v207
    v_add_f32 v12, v12, v74
    v_add_f32 v13, v13, v75
    v_cvt_pk_bf16_f32 v141, v12, v13
    s_mov_b32 s23, 0
    buffer_store_dwordx2 v[140:141], v14, s[32:35], s23 offen offset:32
    s_waitcnt lgkmcnt(2)
    v_lshlrev_b32 v8, 16, v142
    v_and_b32 v9, 0xffff0000, v142
    v_add_f32 v76, v76, v8
    v_add_f32 v77, v77, v9
    v_fma_f32 v8, v8, v171, v170
    v_fma_f32 v9, v9, v171, v170
    v_lshlrev_b32 v12, 16, v182
    v_and_b32 v13, 0xffff0000, v182
    v_fmac_f32 v12, v8, v204
    v_fmac_f32 v13, v9, v205
    v_add_f32 v12, v12, v76
    v_add_f32 v13, v13, v77
    v_cvt_pk_bf16_f32 v142, v12, v13
    v_lshlrev_b32 v8, 16, v143
    v_and_b32 v9, 0xffff0000, v143
    v_add_f32 v78, v78, v8
    v_add_f32 v79, v79, v9
    v_fma_f32 v8, v8, v171, v170
    v_fma_f32 v9, v9, v171, v170
    v_lshlrev_b32 v12, 16, v183
    v_and_b32 v13, 0xffff0000, v183
    v_fmac_f32 v12, v8, v206
    v_fmac_f32 v13, v9, v207
    v_add_f32 v12, v12, v78
    v_add_f32 v13, v13, v79
    v_cvt_pk_bf16_f32 v143, v12, v13
    s_mov_b32 s23, 20480
    buffer_store_dwordx2 v[142:143], v14, s[32:35], s23 offen offset:32
    s_waitcnt lgkmcnt(1)
    v_lshlrev_b32 v8, 16, v144
    v_and_b32 v9, 0xffff0000, v144
    v_add_f32 v80, v80, v8
    v_add_f32 v81, v81, v9
    v_fma_f32 v8, v8, v169, v168
    v_fma_f32 v9, v9, v169, v168
    v_lshlrev_b32 v12, 16, v184
    v_and_b32 v13, 0xffff0000, v184
    v_fmac_f32 v12, v8, v208
    v_fmac_f32 v13, v9, v209
    v_add_f32 v12, v12, v80
    v_add_f32 v13, v13, v81
    v_cvt_pk_bf16_f32 v144, v12, v13
    v_lshlrev_b32 v8, 16, v145
    v_and_b32 v9, 0xffff0000, v145
    v_add_f32 v82, v82, v8
    v_add_f32 v83, v83, v9
    v_fma_f32 v8, v8, v169, v168
    v_fma_f32 v9, v9, v169, v168
    v_lshlrev_b32 v12, 16, v185
    v_and_b32 v13, 0xffff0000, v185
    v_fmac_f32 v12, v8, v210
    v_fmac_f32 v13, v9, v211
    v_add_f32 v12, v12, v82
    v_add_f32 v13, v13, v83
    v_cvt_pk_bf16_f32 v145, v12, v13
    s_mov_b32 s23, 0
    buffer_store_dwordx2 v[144:145], v14, s[32:35], s23 offen offset:64
    s_waitcnt lgkmcnt(0)
    v_lshlrev_b32 v8, 16, v146
    v_and_b32 v9, 0xffff0000, v146
    v_add_f32 v84, v84, v8
    v_add_f32 v85, v85, v9
    v_fma_f32 v8, v8, v171, v170
    v_fma_f32 v9, v9, v171, v170
    v_lshlrev_b32 v12, 16, v186
    v_and_b32 v13, 0xffff0000, v186
    v_fmac_f32 v12, v8, v208
    v_fmac_f32 v13, v9, v209
    v_add_f32 v12, v12, v84
    v_add_f32 v13, v13, v85
    v_cvt_pk_bf16_f32 v146, v12, v13
    v_lshlrev_b32 v8, 16, v147
    v_and_b32 v9, 0xffff0000, v147
    v_add_f32 v86, v86, v8
    v_add_f32 v87, v87, v9
    v_fma_f32 v8, v8, v171, v170
    v_fma_f32 v9, v9, v171, v170
    v_lshlrev_b32 v12, 16, v187
    v_and_b32 v13, 0xffff0000, v187
    v_fmac_f32 v12, v8, v210
    v_fmac_f32 v13, v9, v211
    v_add_f32 v12, v12, v86
    v_add_f32 v13, v13, v87
    v_cvt_pk_bf16_f32 v147, v12, v13
    s_mov_b32 s23, 20480
    buffer_store_dwordx2 v[146:147], v14, s[32:35], s23 offen offset:64
    s_branch g_end
g_b:
    v_and_b32 v14, 15, v1
    v_lshrrev_b32 v15, 4, v1
    s_lshl_b32 s21, s60, 6
    s_lshl_b32 s23, s43, 5
    s_add_u32 s21, s21, s23
    v_add_u32 v14, s21, v14
    v_mov_b32 v16, v14
    v_and_b32 v17, 7, v16
    v_lshrrev_b32 v16, 3, v16
    v_lshlrev_b32 v16, 7, v16
    v_lshl_add_u32 v16, v17, 3, v16
    v_mul_u32_u24 v14, 1280, v14
    v_lshl_add_u32 v14, v15, 3, v14
    s_mul_i32 s20, s61, 80
    s_mul_i32 s21, s44, 48
    s_add_u32 s20, s20, s21
    s_lshl_b32 s22, s20, 1
    v_add_u32 v14, s22, v14
    v_lshlrev_b32 v15, 3, v15
    v_add_u32 v15, s22, v15
    v_lshrrev_b32 v13, 2, v1
    v_add_u32 v13, s20, v13
    v_mul_u32_u24 v13, 4224, v13
    v_and_b32 v17, 3, v1
    v_lshl_add_u32 v10, v17, 4, v13
    v_cmp_gt_u32 vcc, 32, v1
    s_nop 1
    v_cndmask_b32 v11, 0, v1, vcc
    v_add_u32 v11, s20, v11
    v_lshlrev_b32 v11, 7, v11
    v_and_b32 v17, 15, v1
    s_lshr_b32 s21, s60, 1
    s_lshl_b32 s21, s21, 4
    v_add_u32 v17, s21, v17
    v_lshlrev_b32 v17, 7, v17
    v_lshlrev_b32 v13, 7, v1
    s_waitcnt vmcnt(0)
    s_barrier
    v_cmp_ne_u32 vcc, s70, v34
    s_nop 4
    s_cbranch_vccz g_2b_wok
    s_mov_b32 s20, 4096
    s_mov_b32 s21, 180224
g_2b_pw_pl:
    buffer_load_dword v34, v33, s[72:75], s21 offen sc1
    s_waitcnt vmcnt(0)
    v_xor_b32 v34, s70, v34
    v_cmp_ne_u32 vcc, 0, v34
    s_sub_u32 s20, s20, 1
    s_cmp_eq_u32 s20, 0
    s_cbranch_scc1 g_2b_pw_pd
    s_nop 1
    s_cbranch_vccz g_2b_pw_pd
    s_sleep 4
    s_branch g_2b_pw_pl
g_2b_pw_pd:
g_2b_wok:
    s_add_u32 s20, s67, 0
    s_cmp_ge_u32 s20, 24
    s_cselect_b32 s21, 24, 0
    s_sub_u32 s20, s20, s21
    s_lshl_b32 s45, s20, 11
    s_mul_i32 s46, s20, 10240
    s_add_u32 m0, s41, 0
    s_nop 0
    buffer_load_dwordx4 v3, s[28:31], s46 offen offset:0 sc1 lds
    s_add_u32 m0, s41, 0
    s_nop 0
    buffer_load_dwordx4 v3, s[28:31], s46 offen offset:1024 sc1 lds
    s_add_u32 m0, s41, 0
    s_nop 0
    buffer_load_dwordx4 v3, s[28:31], s46 offen offset:2048 sc1 lds
    s_add_u32 s20, s67, 1
    s_cmp_ge_u32 s20, 24
    s_cselect_b32 s21, 24, 0
    s_sub_u32 s20, s20, s21
    s_lshl_b32 s45, s20, 11
    s_mul_i32 s46, s20, 10240
    s_add_u32 m0, s41, 18432
    s_nop 0
    buffer_load_dwordx4 v3, s[28:31], s46 offen offset:0 sc1 lds
    s_add_u32 m0, s41, 18432
    s_nop 0
    buffer_load_dwordx4 v3, s[28:31], s46 offen offset:1024 sc1 lds
    s_add_u32 m0, s41, 18432
    s_nop 0
    buffer_load_dwordx4 v3, s[28:31], s46 offen offset:2048 sc1 lds
    s_add_u32 s20, s67, 2
    s_cmp_ge_u32 s20, 24
    s_cselect_b32 s21, 24, 0
    s_sub_u32 s20, s20, s21
    s_lshl_b32 s45, s20, 11
    s_mul_i32 s46, s20, 10240
    s_add_u32 m0, s41, 36864
    s_nop 0
    buffer_load_dwordx4 v3, s[28:31], s46 offen offset:0 sc1 lds
    s_add_u32 m0, s41, 36864
    s_nop 0
    buffer_load_dwordx4 v3, s[28:31], s46 offen offset:1024 sc1 lds
    s_add_u32 m0, s41, 36864
    s_nop 0
    buffer_load_dwordx4 v3, s[28:31], s46 offen offset:2048 sc1 lds
    s_add_u32 s20, s67, 3
    s_cmp_ge_u32 s20, 24
    s_cselect_b32 s21, 24, 0
    s_sub_u32 s20, s20, s21
    s_lshl_b32 s45, s20, 11
    s_mul_i32 s46, s20, 10240
    s_add_u32 m0, s41, 55296
    s_nop 0
    buffer_load_dwordx4 v3, s[28:31], s46 offen offset:0 sc1 lds
    s_add_u32 m0, s41, 55296
    s_nop 0
    buffer_load_dwordx4 v3, s[28:31], s46 offen offset:1024 sc1 lds
    s_add_u32 m0, s41, 55296
    s_nop 0
    buffer_load_dwordx4 v3, s[28:31], s46 offen offset:2048 sc1 lds
    buffer_load_dwordx2 v[160:161], v15, s[56:59], 0 offen offset:0
    s_mov_b32 s23, 0
    buffer_load_dwordx2 v[136:137], v14, s[24:27], s23 offen offset:0
    s_mov_b32 s23, 20480
    buffer_load_dwordx2 v[138:139], v14, s[24:27], s23 offen offset:0
    buffer_load_dwordx2 v[162:163], v15, s[56:59], 0 offen offset:32
    s_mov_b32 s23, 0
    buffer_load_dwordx2 v[140:141], v14, s[24:27], s23 offen offset:32
    s_mov_b32 s23, 20480
    buffer_load_dwordx2 v[142:143], v14, s[24:27], s23 offen offset:32
    s_barrier
    buffer_load_dwordx2 v[168:169], v16, s[48:51], 0 offen sc1
    buffer_load_dwordx2 v[170:171], v16, s[48:51], 0 offen offset:256 sc1
    s_add_u32 s20, s67, 0
    s_cmp_ge_u32 s20, 24
    s_cselect_b32 s21, 24, 0
    s_sub_u32 s20, s20, s21
    s_lshl_b32 s45, s20, 11
    s_mul_i32 s46, s20, 10240
    s_add_u32 m0, s40, 0
    s_nop 0
    buffer_load_dwordx4 v2, s[36:39], s45 offen sc1 lds
    s_add_u32 m0, s40, 4096
    s_add_u32 s47, s45, 1024
    buffer_load_dwordx4 v2, s[36:39], s47 offen sc1 lds
    s_add_u32 s20, s67, 1
    s_cmp_ge_u32 s20, 24
    s_cselect_b32 s21, 24, 0
    s_sub_u32 s20, s20, s21
    s_lshl_b32 s45, s20, 11
    s_mul_i32 s46, s20, 10240
    s_add_u32 m0, s40, 18432
    s_nop 0
    buffer_load_dwordx4 v2, s[36:39], s45 offen sc1 lds
    s_add_u32 m0, s40, 22528
    s_add_u32 s47, s45, 1024
    buffer_load_dwordx4 v2, s[36:39], s47 offen sc1 lds
    s_add_u32 s20, s67, 2
    s_cmp_ge_u32 s20, 24
    s_cselect_b32 s21, 24, 0
    s_sub_u32 s20, s20, s21
    s_lshl_b32 s45, s20, 11
    s_mul_i32 s46, s20, 10240
    s_add_u32 m0, s40, 36864
    s_nop 0
    buffer_load_dwordx4 v2, s[36:39], s45 offen sc1 lds
    s_add_u32 m0, s40, 40960
    s_add_u32 s47, s45, 1024
    buffer_load_dwordx4 v2, s[36:39], s47 offen sc1 lds
    s_add_u32 s20, s67, 3
    s_cmp_ge_u32 s20, 24
    s_cselect_b32 s21, 24, 0
    s_sub_u32 s20, s20, s21
    s_lshl_b32 s45, s20, 11
    s_mul_i32 s46, s20, 10240
    s_add_u32 m0, s40, 55296
    s_nop 0
    buffer_load_dwordx4 v2, s[36:39], s45 offen sc1 lds
    s_add_u32 m0, s40, 59392
    s_add_u32 s47, s45, 1024
    buffer_load_dwordx4 v2, s[36:39], s47 offen sc1 lds
    s_waitcnt vmcnt(6)
    s_barrier
    ds_read_b128 v[96:99], v6 offset:0
    ds_read_b128 v[100:103], v6 offset:1024
    ds_read_b64_tr_b16 v[104:105], v7 offset:0
    ds_read_b64_tr_b16 v[106:107], v7 offset:1280
    ds_read_b64_tr_b16 v[108:109], v7 offset:32
    ds_read_b64_tr_b16 v[110:111], v7 offset:1312
    s_add_u32 s20, s67, 3
    s_cmp_ge_u32 s20, 24
    s_cselect_b32 s21, 24, 0
    s_sub_u32 s20, s20, s21
    s_lshl_b32 s45, s20, 11
    s_mul_i32 s46, s20, 10240
    s_waitcnt lgkmcnt(0)
    ds_read_b128 v[116:119], v6 offset:4096
    ds_read_b128 v[120:123], v6 offset:5120
    ds_read_b64_tr_b16 v[124:125], v7 offset:5120
    ds_read_b64_tr_b16 v[126:127], v7 offset:6400
    ds_read_b64_tr_b16 v[128:129], v7 offset:5152
    ds_read_b64_tr_b16 v[130:131], v7 offset:6432
    v_mfma_f32_16x16x32_bf16 v[64:67], v[104:107], v[96:99], v[64:67]
    v_mfma_f32_16x16x32_bf16 v[68:71], v[104:107], v[100:103], v[68:71]
    v_mfma_f32_16x16x32_bf16 v[72:75], v[108:111], v[96:99], v[72:75]
    v_mfma_f32_16x16x32_bf16 v[76:79], v[108:111], v[100:103], v[76:79]
    s_add_u32 s45, s45, 2048
    s_cmp_ge_u32 s45, s64
    s_cselect_b32 s21, s64, 0
    s_sub_u32 s45, s45, s21
    s_add_u32 s46, s46, 10240
    s_cmp_ge_u32 s46, s65
    s_cselect_b32 s21, s65, 0
    s_sub_u32 s46, s46, s21
    s_waitcnt vmcnt(4) lgkmcnt(0)
    s_barrier
    ds_read_b128 v[96:99], v6 offset:18432
    ds_read_b128 v[100:103], v6 offset:19456
    ds_read_b64_tr_b16 v[104:105], v7 offset:18432
    ds_read_b64_tr_b16 v[106:107], v7 offset:19712
    ds_read_b64_tr_b16 v[108:109], v7 offset:18464
    ds_read_b64_tr_b16 v[110:111], v7 offset:19744
    v_mfma_f32_16x16x32_bf16 v[64:67], v[124:127], v[116:119], v[64:67]
    s_add_u32 m0, s40, 0
    s_nop 0
    buffer_load_dwordx4 v2, s[36:39], s45 offen sc1 lds
    v_mfma_f32_16x16x32_bf16 v[68:71], v[124:127], v[120:123], v[68:71]
    v_mfma_f32_16x16x32_bf16 v[72:75], v[128:131], v[116:119], v[72:75]
    s_add_u32 m0, s40, 4096
    s_add_u32 s47, s45, 1024
    buffer_load_dwordx4 v2, s[36:39], s47 offen sc1 lds
    v_mfma_f32_16x16x32_bf16 v[76:79], v[128:131], v[120:123], v[76:79]
    s_add_u32 m0, s41, 0
    s_nop 0
    buffer_load_dwordx4 v3, s[28:31], s46 offen offset:0 sc1 lds
    s_waitcnt lgkmcnt(0)
    ds_read_b128 v[116:119], v6 offset:22528
    ds_read_b128 v[120:123], v6 offset:23552
    ds_read_b64_tr_b16 v[124:125], v7 offset:23552
    ds_read_b64_tr_b16 v[126:127], v7 offset:24832
    ds_read_b64_tr_b16 v[128:129], v7 offset:23584
    ds_read_b64_tr_b16 v[130:131], v7 offset:24864
    v_mfma_f32_16x16x32_bf16 v[64:67], v[104:107], v[96:99], v[64:67]
    v_mfma_f32_16x16x32_bf16 v[68:71], v[104:107], v[100:103], v[68:71]
    s_add_u32 m0, s41, 0
    s_nop 0
    buffer_load_dwordx4 v3, s[28:31], s46 offen offset:1024 sc1 lds
    v_mfma_f32_16x16x32_bf16 v[72:75], v[108:111], v[96:99], v[72:75]
    v_mfma_f32_16x16x32_bf16 v[76:79], v[108:111], v[100:103], v[76:79]
    s_add_u32 m0, s41, 0
    s_nop 0
    buffer_load_dwordx4 v3, s[28:31], s46 offen offset:2048 sc1 lds
    s_add_u32 s45, s45, 2048
    s_cmp_ge_u32 s45, s64
    s_cselect_b32 s21, s64, 0
    s_sub_u32 s45, s45, s21
    s_add_u32 s46, s46, 10240
    s_cmp_ge_u32 s46, s65
    s_cselect_b32 s21, s65, 0
    s_sub_u32 s46, s46, s21
    s_waitcnt vmcnt(7) lgkmcnt(0)
    s_barrier
    ds_read_b128 v[96:99], v6 offset:36864
    ds_read_b128 v[100:103], v6 offset:37888
    ds_read_b64_tr_b16 v[104:105], v7 offset:36864
    ds_read_b64_tr_b16 v[106:107], v7 offset:38144
    ds_read_b64_tr_b16 v[108:109], v7 offset:36896
    ds_read_b64_tr_b16 v[110:111], v7 offset:38176
    v_mfma_f32_16x16x32_bf16 v[64:67], v[124:127], v[116:119], v[64:67]
    s_add_u32 m0, s40, 18432
    s_nop 0
    buffer_load_dwordx4 v2, s[36:39], s45 offen sc1 lds
    v_mfma_f32_16x16x32_bf16 v[68:71], v[124:127], v[120:123], v[68:71]
    v_mfma_f32_16x16x32_bf16 v[72:75], v[128:131], v[116:119], v[72:75]
    s_add_u32 m0, s40, 22528
    s_add_u32 s47, s45, 1024
    buffer_load_dwordx4 v2, s[36:39], s47 offen sc1 lds
    v_mfma_f32_16x16x32_bf16 v[76:79], v[128:131], v[120:123], v[76:79]
    s_add_u32 m0, s41, 18432
    s_nop 0
    buffer_load_dwordx4 v3, s[28:31], s46 offen offset:0 sc1 lds
    s_waitcnt lgkmcnt(0)
    ds_read_b128 v[116:119], v6 offset:40960
    ds_read_b128 v[120:123], v6 offset:41984
    ds_read_b64_tr_b16 v[124:125], v7 offset:41984
    ds_read_b64_tr_b16 v[126:127], v7 offset:43264
    ds_read_b64_tr_b16 v[128:129], v7 offset:42016
    ds_read_b64_tr_b16 v[130:131], v7 offset:43296
    v_mfma_f32_16x16x32_bf16 v[64:67], v[104:107], v[96:99], v[64:67]
    v_mfma_f32_16x16x32_bf16 v[68:71], v[104:107], v[100:103], v[68:71]
    s_add_u32 m0, s41, 18432
    s_nop 0
    buffer_load_dwordx4 v3, s[28:31], s46 offen offset:1024 sc1 lds
    v_mfma_f32_16x16x32_bf16 v[72:75], v[108:111], v[96:99], v[72:75]
    v_mfma_f32_16x16x32_bf16 v[76:79], v[108:111], v[100:103], v[76:79]
    s_add_u32 m0, s41, 18432
    s_nop 0
    buffer_load_dwordx4 v3, s[28:31], s46 offen offset:2048 sc1 lds
    s_add_u32 s45, s45, 2048
    s_cmp_ge_u32 s45, s64
    s_cselect_b32 s21, s64, 0
    s_sub_u32 s45, s45, s21
    s_add_u32 s46, s46, 10240
    s_cmp_ge_u32 s46, s65
    s_cselect_b32 s21, s65, 0
    s_sub_u32 s46, s46, s21
    s_waitcnt vmcnt(10) lgkmcnt(0)
    s_barrier
    ds_read_b128 v[96:99], v6 offset:55296
    ds_read_b128 v[100:103], v6 offset:56320
    ds_read_b64_tr_b16 v[104:105], v7 offset:55296
    ds_read_b64_tr_b16 v[106:107], v7 offset:56576
    ds_read_b64_tr_b16 v[108:109], v7 offset:55328
    ds_read_b64_tr_b16 v[110:111], v7 offset:56608
    v_mfma_f32_16x16x32_bf16 v[64:67], v[124:127], v[116:119], v[64:67]
    s_add_u32 m0, s40, 36864
    s_nop 0
    buffer_load_dwordx4 v2, s[36:39], s45 offen sc1 lds
    v_mfma_f32_16x16x32_bf16 v[68:71], v[124:127], v[120:123], v[68:71]
    v_mfma_f32_16x16x32_bf16 v[72:75], v[128:131], v[116:119], v[72:75]
    s_add_u32 m0, s40, 40960
    s_add_u32 s47, s45, 1024
    buffer_load_dwordx4 v2, s[36:39], s47 offen sc1 lds
    v_mfma_f32_16x16x32_bf16 v[76:79], v[128:131], v[120:123], v[76:79]
    s_add_u32 m0, s41, 36864
    s_nop 0
    buffer_load_dwordx4 v3, s[28:31], s46 offen offset:0 sc1 lds
    s_waitcnt lgkmcnt(0)
    ds_read_b128 v[116:119], v6 offset:59392
    ds_read_b128 v[120:123], v6 offset:60416
    ds_read_b64_tr_b16 v[124:125], v7 offset:60416
    ds_read_b64_tr_b16 v[126:127], v7 offset:61696
    ds_read_b64_tr_b16 v[128:129], v7 offset:60448
    ds_read_b64_tr_b16 v[130:131], v7 offset:61728
    v_mfma_f32_16x16x32_bf16 v[64:67], v[104:107], v[96:99], v[64:67]
    v_mfma_f32_16x16x32_bf16 v[68:71], v[104:107], v[100:103], v[68:71]
    s_add_u32 m0, s41, 36864
    s_nop 0
    buffer_load_dwordx4 v3, s[28:31], s46 offen offset:1024 sc1 lds
    v_mfma_f32_16x16x32_bf16 v[72:75], v[108:111], v[96:99], v[72:75]
    v_mfma_f32_16x16x32_bf16 v[76:79], v[108:111], v[100:103], v[76:79]
    s_add_u32 m0, s41, 36864
    s_nop 0
    buffer_load_dwordx4 v3, s[28:31], s46 offen offset:2048 sc1 lds
    s_add_u32 s45, s45, 2048
    s_cmp_ge_u32 s45, s64
    s_cselect_b32 s21, s64, 0
    s_sub_u32 s45, s45, s21
    s_add_u32 s46, s46, 10240
    s_cmp_ge_u32 s46, s65
    s_cselect_b32 s21, s65, 0
    s_sub_u32 s46, s46, s21
    s_waitcnt vmcnt(10) lgkmcnt(0)
    s_barrier
    ds_read_b128 v[96:99], v6 offset:0
    ds_read_b128 v[100:103], v6 offset:1024
    ds_read_b64_tr_b16 v[104:105], v7 offset:0
    ds_read_b64_tr_b16 v[106:107], v7 offset:1280
    ds_read_b64_tr_b16 v[108:109], v7 offset:32
    ds_read_b64_tr_b16 v[110:111], v7 offset:1312
    v_mfma_f32_16x16x32_bf16 v[64:67], v[124:127], v[116:119], v[64:67]
    s_add_u32 m0, s40, 55296
    s_nop 0
    buffer_load_dwordx4 v2, s[36:39], s45 offen sc1 lds
    v_mfma_f32_16x16x32_bf16 v[68:71], v[124:127], v[120:123], v[68:71]
    v_mfma_f32_16x16x32_bf16 v[72:75], v[128:131], v[116:119], v[72:75]
    s_add_u32 m0, s40, 59392
    s_add_u32 s47, s45, 1024
    buffer_load_dwordx4 v2, s[36:39], s47 offen sc1 lds
    v_mfma_f32_16x16x32_bf16 v[76:79], v[128:131], v[120:123], v[76:79]
    s_add_u32 m0, s41, 55296
    s_nop 0
    buffer_load_dwordx4 v3, s[28:31], s46 offen offset:0 sc1 lds
    s_mov_b32 s63, 4
g_2b_loop:
    s_waitcnt lgkmcnt(0)
    ds_read_b128 v[116:119], v6 offset:4096
    ds_read_b128 v[120:123], v6 offset:5120
    ds_read_b64_tr_b16 v[124:125], v7 offset:5120
    ds_read_b64_tr_b16 v[126:127], v7 offset:6400
    ds_read_b64_tr_b16 v[128:129], v7 offset:5152
    ds_read_b64_tr_b16 v[130:131], v7 offset:6432
    v_mfma_f32_16x16x32_bf16 v[64:67], v[104:107], v[96:99], v[64:67]
    v_mfma_f32_16x16x32_bf16 v[68:71], v[104:107], v[100:103], v[68:71]
    s_add_u32 m0, s41, 55296
    s_nop 0
    buffer_load_dwordx4 v3, s[28:31], s46 offen offset:1024 sc1 lds
    v_mfma_f32_16x16x32_bf16 v[72:75], v[108:111], v[96:99], v[72:75]
    v_mfma_f32_16x16x32_bf16 v[76:79], v[108:111], v[100:103], v[76:79]
    s_add_u32 m0, s41, 55296
    s_nop 0
    buffer_load_dwordx4 v3, s[28:31], s46 offen offset:2048 sc1 lds
    s_add_u32 s45, s45, 2048
    s_cmp_ge_u32 s45, s64
    s_cselect_b32 s21, s64, 0
    s_sub_u32 s45, s45, s21
    s_add_u32 s46, s46, 10240
    s_cmp_ge_u32 s46, s65
    s_cselect_b32 s21, s65, 0
    s_sub_u32 s46, s46, s21
    s_waitcnt vmcnt(10) lgkmcnt(0)
    s_barrier
    ds_read_b128 v[96:99], v6 offset:18432
    ds_read_b128 v[100:103], v6 offset:19456
    ds_read_b64_tr_b16 v[104:105], v7 offset:18432
    ds_read_b64_tr_b16 v[106:107], v7 offset:19712
    ds_read_b64_tr_b16 v[108:109], v7 offset:18464
    ds_read_b64_tr_b16 v[110:111], v7 offset:19744
    v_mfma_f32_16x16x32_bf16 v[64:67], v[124:127], v[116:119], v[64:67]
    s_add_u32 m0, s40, 0
    s_nop 0
    buffer_load_dwordx4 v2, s[36:39], s45 offen sc1 lds
    v_mfma_f32_16x16x32_bf16 v[68:71], v[124:127], v[120:123], v[68:71]
    v_mfma_f32_16x16x32_bf16 v[72:75], v[128:131], v[116:119], v[72:75]
    s_add_u32 m0, s40, 4096
    s_add_u32 s47, s45, 1024
    buffer_load_dwordx4 v2, s[36:39], s47 offen sc1 lds
    v_mfma_f32_16x16x32_bf16 v[76:79], v[128:131], v[120:123], v[76:79]
    s_add_u32 m0, s41, 0
    s_nop 0
    buffer_load_dwordx4 v3, s[28:31], s46 offen offset:0 sc1 lds
    s_waitcnt lgkmcnt(0)
    ds_read_b128 v[116:119], v6 offset:22528
    ds_read_b128 v[120:123], v6 offset:23552
    ds_read_b64_tr_b16 v[124:125], v7 offset:23552
    ds_read_b64_tr_b16 v[126:127], v7 offset:24832
    ds_read_b64_tr_b16 v[128:129], v7 offset:23584
    ds_read_b64_tr_b16 v[130:131], v7 offset:24864
    v_mfma_f32_16x16x32_bf16 v[64:67], v[104:107], v[96:99], v[64:67]
    v_mfma_f32_16x16x32_bf16 v[68:71], v[104:107], v[100:103], v[68:71]
    s_add_u32 m0, s41, 0
    s_nop 0
    buffer_load_dwordx4 v3, s[28:31], s46 offen offset:1024 sc1 lds
    v_mfma_f32_16x16x32_bf16 v[72:75], v[108:111], v[96:99], v[72:75]
    v_mfma_f32_16x16x32_bf16 v[76:79], v[108:111], v[100:103], v[76:79]
    s_add_u32 m0, s41, 0
    s_nop 0
    buffer_load_dwordx4 v3, s[28:31], s46 offen offset:2048 sc1 lds
    s_add_u32 s45, s45, 2048
    s_cmp_ge_u32 s45, s64
    s_cselect_b32 s21, s64, 0
    s_sub_u32 s45, s45, s21
    s_add_u32 s46, s46, 10240
    s_cmp_ge_u32 s46, s65
    s_cselect_b32 s21, s65, 0
    s_sub_u32 s46, s46, s21
    s_waitcnt vmcnt(10) lgkmcnt(0)
    s_barrier
    ds_read_b128 v[96:99], v6 offset:36864
    ds_read_b128 v[100:103], v6 offset:37888
    ds_read_b64_tr_b16 v[104:105], v7 offset:36864
    ds_read_b64_tr_b16 v[106:107], v7 offset:38144
    ds_read_b64_tr_b16 v[108:109], v7 offset:36896
    ds_read_b64_tr_b16 v[110:111], v7 offset:38176
    v_mfma_f32_16x16x32_bf16 v[64:67], v[124:127], v[116:119], v[64:67]
    s_add_u32 m0, s40, 18432
    s_nop 0
    buffer_load_dwordx4 v2, s[36:39], s45 offen sc1 lds
    v_mfma_f32_16x16x32_bf16 v[68:71], v[124:127], v[120:123], v[68:71]
    v_mfma_f32_16x16x32_bf16 v[72:75], v[128:131], v[116:119], v[72:75]
    s_add_u32 m0, s40, 22528
    s_add_u32 s47, s45, 1024
    buffer_load_dwordx4 v2, s[36:39], s47 offen sc1 lds
    v_mfma_f32_16x16x32_bf16 v[76:79], v[128:131], v[120:123], v[76:79]
    s_add_u32 m0, s41, 18432
    s_nop 0
    buffer_load_dwordx4 v3, s[28:31], s46 offen offset:0 sc1 lds
    s_waitcnt lgkmcnt(0)
    ds_read_b128 v[116:119], v6 offset:40960
    ds_read_b128 v[120:123], v6 offset:41984
    ds_read_b64_tr_b16 v[124:125], v7 offset:41984
    ds_read_b64_tr_b16 v[126:127], v7 offset:43264
    ds_read_b64_tr_b16 v[128:129], v7 offset:42016
    ds_read_b64_tr_b16 v[130:131], v7 offset:43296
    v_mfma_f32_16x16x32_bf16 v[64:67], v[104:107], v[96:99], v[64:67]
    v_mfma_f32_16x16x32_bf16 v[68:71], v[104:107], v[100:103], v[68:71]
    s_add_u32 m0, s41, 18432
    s_nop 0
    buffer_load_dwordx4 v3, s[28:31], s46 offen offset:1024 sc1 lds
    v_mfma_f32_16x16x32_bf16 v[72:75], v[108:111], v[96:99], v[72:75]
    v_mfma_f32_16x16x32_bf16 v[76:79], v[108:111], v[100:103], v[76:79]
    s_add_u32 m0, s41, 18432
    s_nop 0
    buffer_load_dwordx4 v3, s[28:31], s46 offen offset:2048 sc1 lds
    s_add_u32 s45, s45, 2048
    s_cmp_ge_u32 s45, s64
    s_cselect_b32 s21, s64, 0
    s_sub_u32 s45, s45, s21
    s_add_u32 s46, s46, 10240
    s_cmp_ge_u32 s46, s65
    s_cselect_b32 s21, s65, 0
    s_sub_u32 s46, s46, s21
    s_waitcnt vmcnt(10) lgkmcnt(0)
    s_barrier
    ds_read_b128 v[96:99], v6 offset:55296
    ds_read_b128 v[100:103], v6 offset:56320
    ds_read_b64_tr_b16 v[104:105], v7 offset:55296
    ds_read_b64_tr_b16 v[106:107], v7 offset:56576
    ds_read_b64_tr_b16 v[108:109], v7 offset:55328
    ds_read_b64_tr_b16 v[110:111], v7 offset:56608
    v_mfma_f32_16x16x32_bf16 v[64:67], v[124:127], v[116:119], v[64:67]
    s_add_u32 m0, s40, 36864
    s_nop 0
    buffer_load_dwordx4 v2, s[36:39], s45 offen sc1 lds
    v_mfma_f32_16x16x32_bf16 v[68:71], v[124:127], v[120:123], v[68:71]
    v_mfma_f32_16x16x32_bf16 v[72:75], v[128:131], v[116:119], v[72:75]
    s_add_u32 m0, s40, 40960
    s_add_u32 s47, s45, 1024
    buffer_load_dwordx4 v2, s[36:39], s47 offen sc1 lds
    v_mfma_f32_16x16x32_bf16 v[76:79], v[128:131], v[120:123], v[76:79]
    s_add_u32 m0, s41, 36864
    s_nop 0
    buffer_load_dwordx4 v3, s[28:31], s46 offen offset:0 sc1 lds
    s_waitcnt lgkmcnt(0)
    ds_read_b128 v[116:119], v6 offset:59392
    ds_read_b128 v[120:123], v6 offset:60416
    ds_read_b64_tr_b16 v[124:125], v7 offset:60416
    ds_read_b64_tr_b16 v[126:127], v7 offset:61696
    ds_read_b64_tr_b16 v[128:129], v7 offset:60448
    ds_read_b64_tr_b16 v[130:131], v7 offset:61728
    v_mfma_f32_16x16x32_bf16 v[64:67], v[104:107], v[96:99], v[64:67]
    v_mfma_f32_16x16x32_bf16 v[68:71], v[104:107], v[100:103], v[68:71]
    s_add_u32 m0, s41, 36864
    s_nop 0
    buffer_load_dwordx4 v3, s[28:31], s46 offen offset:1024 sc1 lds
    v_mfma_f32_16x16x32_bf16 v[72:75], v[108:111], v[96:99], v[72:75]
    v_mfma_f32_16x16x32_bf16 v[76:79], v[108:111], v[100:103], v[76:79]
    s_add_u32 m0, s41, 36864
    s_nop 0
    buffer_load_dwordx4 v3, s[28:31], s46 offen offset:2048 sc1 lds
    s_add_u32 s45, s45, 2048
    s_cmp_ge_u32 s45, s64
    s_cselect_b32 s21, s64, 0
    s_sub_u32 s45, s45, s21
    s_add_u32 s46, s46, 10240
    s_cmp_ge_u32 s46, s65
    s_cselect_b32 s21, s65, 0
    s_sub_u32 s46, s46, s21
    s_waitcnt vmcnt(10) lgkmcnt(0)
    s_barrier
    ds_read_b128 v[96:99], v6 offset:0
    ds_read_b128 v[100:103], v6 offset:1024
    ds_read_b64_tr_b16 v[104:105], v7 offset:0
    ds_read_b64_tr_b16 v[106:107], v7 offset:1280
    ds_read_b64_tr_b16 v[108:109], v7 offset:32
    ds_read_b64_tr_b16 v[110:111], v7 offset:1312
    v_mfma_f32_16x16x32_bf16 v[64:67], v[124:127], v[116:119], v[64:67]
    s_add_u32 m0, s40, 55296
    s_nop 0
    buffer_load_dwordx4 v2, s[36:39], s45 offen sc1 lds
    v_mfma_f32_16x16x32_bf16 v[68:71], v[124:127], v[120:123], v[68:71]
    v_mfma_f32_16x16x32_bf16 v[72:75], v[128:131], v[116:119], v[72:75]
    s_add_u32 m0, s40, 59392
    s_add_u32 s47, s45, 1024
    buffer_load_dwordx4 v2, s[36:39], s47 offen sc1 lds
    v_mfma_f32_16x16x32_bf16 v[76:79], v[128:131], v[120:123], v[76:79]
    s_add_u32 m0, s41, 55296
    s_nop 0
    buffer_load_dwordx4 v3, s[28:31], s46 offen offset:0 sc1 lds
    s_sub_u32 s63, s63, 1
    s_cmp_lg_u32 s63, 0
    s_cbranch_scc1 g_2b_loop
    s_waitcnt lgkmcnt(0)
    ds_read_b128 v[116:119], v6 offset:4096
    ds_read_b128 v[120:123], v6 offset:5120
    ds_read_b64_tr_b16 v[124:125], v7 offset:5120
    ds_read_b64_tr_b16 v[126:127], v7 offset:6400
    ds_read_b64_tr_b16 v[128:129], v7 offset:5152
    ds_read_b64_tr_b16 v[130:131], v7 offset:6432
    v_mfma_f32_16x16x32_bf16 v[64:67], v[104:107], v[96:99], v[64:67]
    v_mfma_f32_16x16x32_bf16 v[68:71], v[104:107], v[100:103], v[68:71]
    s_add_u32 m0, s41, 55296
    s_nop 0
    buffer_load_dwordx4 v3, s[28:31], s46 offen offset:1024 sc1 lds
    v_mfma_f32_16x16x32_bf16 v[72:75], v[108:111], v[96:99], v[72:75]
    v_mfma_f32_16x16x32_bf16 v[76:79], v[108:111], v[100:103], v[76:79]
    s_add_u32 m0, s41, 55296
    s_nop 0
    buffer_load_dwordx4 v3, s[28:31], s46 offen offset:2048 sc1 lds
    s_add_u32 s45, s45, 2048
    s_cmp_ge_u32 s45, s64
    s_cselect_b32 s21, s64, 0
    s_sub_u32 s45, s45, s21
    s_add_u32 s46, s46, 10240
    s_cmp_ge_u32 s46, s65
    s_cselect_b32 s21, s65, 0
    s_sub_u32 s46, s46, s21
    s_waitcnt vmcnt(10) lgkmcnt(0)
    s_barrier
    ds_read_b128 v[96:99], v6 offset:18432
    ds_read_b128 v[100:103], v6 offset:19456
    ds_read_b64_tr_b16 v[104:105], v7 offset:18432
    ds_read_b64_tr_b16 v[106:107], v7 offset:19712
    ds_read_b64_tr_b16 v[108:109], v7 offset:18464
    ds_read_b64_tr_b16 v[110:111], v7 offset:19744
    s_mov_b32 s20, 65536
    buffer_load_dword v17, v11, s[72:75], s20 offen sc1
    v_mfma_f32_16x16x32_bf16 v[64:67], v[124:127], v[116:119], v[64:67]
    v_mfma_f32_16x16x32_bf16 v[68:71], v[124:127], v[120:123], v[68:71]
    v_mfma_f32_16x16x32_bf16 v[72:75], v[128:131], v[116:119], v[72:75]
    v_mfma_f32_16x16x32_bf16 v[76:79], v[128:131], v[120:123], v[76:79]
    s_waitcnt lgkmcnt(0)
    ds_read_b128 v[116:119], v6 offset:22528
    ds_read_b128 v[120:123], v6 offset:23552
    ds_read_b64_tr_b16 v[124:125], v7 offset:23552
    ds_read_b64_tr_b16 v[126:127], v7 offset:24832
    ds_read_b64_tr_b16 v[128:129], v7 offset:23584
    ds_read_b64_tr_b16 v[130:131], v7 offset:24864
    v_mfma_f32_16x16x32_bf16 v[64:67], v[104:107], v[96:99], v[64:67]
    v_mfma_f32_16x16x32_bf16 v[68:71], v[104:107], v[100:103], v[68:71]
    v_mfma_f32_16x16x32_bf16 v[72:75], v[108:111], v[96:99], v[72:75]
    v_mfma_f32_16x16x32_bf16 v[76:79], v[108:111], v[100:103], v[76:79]
    s_waitcnt vmcnt(6) lgkmcnt(0)
    s_barrier
    ds_read_b128 v[96:99], v6 offset:36864
    ds_read_b128 v[100:103], v6 offset:37888
    ds_read_b64_tr_b16 v[104:105], v7 offset:36864
    ds_read_b64_tr_b16 v[106:107], v7 offset:38144
    ds_read_b64_tr_b16 v[108:109], v7 offset:36896
    ds_read_b64_tr_b16 v[110:111], v7 offset:38176
    v_mfma_f32_16x16x32_bf16 v[64:67], v[124:127], v[116:119], v[64:67]
    v_mfma_f32_16x16x32_bf16 v[68:71], v[124:127], v[120:123], v[68:71]
    v_mfma_f32_16x16x32_bf16 v[72:75], v[128:131], v[116:119], v[72:75]
    v_mfma_f32_16x16x32_bf16 v[76:79], v[128:131], v[120:123], v[76:79]
    s_waitcnt lgkmcnt(0)
    ds_read_b128 v[116:119], v6 offset:40960
    ds_read_b128 v[120:123], v6 offset:41984
    ds_read_b64_tr_b16 v[124:125], v7 offset:41984
    ds_read_b64_tr_b16 v[126:127], v7 offset:43264
    ds_read_b64_tr_b16 v[128:129], v7 offset:42016
    ds_read_b64_tr_b16 v[130:131], v7 offset:43296
    v_mfma_f32_16x16x32_bf16 v[64:67], v[104:107], v[96:99], v[64:67]
    v_mfma_f32_16x16x32_bf16 v[68:71], v[104:107], v[100:103], v[68:71]
    v_mfma_f32_16x16x32_bf16 v[72:75], v[108:111], v[96:99], v[72:75]
    v_mfma_f32_16x16x32_bf16 v[76:79], v[108:111], v[100:103], v[76:79]
    s_waitcnt vmcnt(0) lgkmcnt(0)
    s_barrier
    ds_read_b128 v[96:99], v6 offset:55296
    ds_read_b128 v[100:103], v6 offset:56320
    ds_read_b64_tr_b16 v[104:105], v7 offset:55296
    ds_read_b64_tr_b16 v[106:107], v7 offset:56576
    ds_read_b64_tr_b16 v[108:109], v7 offset:55328
    ds_read_b64_tr_b16 v[110:111], v7 offset:56608
    v_cmp_ne_u32 vcc, s70, v17
    s_nop 4
    s_cbranch_vccz g_2b_yok
    s_mov_b32 s20, 4096
    s_mov_b32 s21, 65536
g_2b_py_pl:
    buffer_load_dword v17, v11, s[72:75], s21 offen sc1
    s_waitcnt vmcnt(0)
    v_xor_b32 v17, s70, v17
    v_cmp_ne_u32 vcc, 0, v17
    s_sub_u32 s20, s20, 1
    s_cmp_eq_u32 s20, 0
    s_cbranch_scc1 g_2b_py_pd
    s_nop 1
    s_cbranch_vccz g_2b_py_pd
    s_sleep 4
    s_branch g_2b_py_pl
g_2b_py_pd:
g_2b_yok:
    s_lshl_b32 s21, s60, 7
    s_lshl_b32 s22, s43, 6
    s_add_u32 s21, s21, s22
    s_mul_i32 s22, s62, 3072
    s_add_u32 m0, s22, 0
    s_add_u32 s23, s21, 0
    buffer_load_dwordx4 v10, s[52:55], s23 offen sc1 lds
    s_add_u32 m0, s22, 1024
    s_add_u32 s23, s21, 67584
    buffer_load_dwordx4 v10, s[52:55], s23 offen sc1 lds
    v_mfma_f32_16x16x32_bf16 v[64:67], v[124:127], v[116:119], v[64:67]
    v_mfma_f32_16x16x32_bf16 v[68:71], v[124:127], v[120:123], v[68:71]
    v_mfma_f32_16x16x32_bf16 v[72:75], v[128:131], v[116:119], v[72:75]
    v_mfma_f32_16x16x32_bf16 v[76:79], v[128:131], v[120:123], v[76:79]
    s_waitcnt lgkmcnt(0)
    ds_read_b128 v[116:119], v6 offset:59392
    ds_read_b128 v[120:123], v6 offset:60416
    ds_read_b64_tr_b16 v[124:125], v7 offset:60416
    ds_read_b64_tr_b16 v[126:127], v7 offset:61696
    ds_read_b64_tr_b16 v[128:129], v7 offset:60448
    ds_read_b64_tr_b16 v[130:131], v7 offset:61728
    v_mfma_f32_16x16x32_bf16 v[64:67], v[104:107], v[96:99], v[64:67]
    v_mfma_f32_16x16x32_bf16 v[68:71], v[104:107], v[100:103], v[68:71]
    v_mfma_f32_16x16x32_bf16 v[72:75], v[108:111], v[96:99], v[72:75]
    v_mfma_f32_16x16x32_bf16 v[76:79], v[108:111], v[100:103], v[76:79]
    s_waitcnt lgkmcnt(0)
    v_mfma_f32_16x16x32_bf16 v[64:67], v[124:127], v[116:119], v[64:67]
    v_mfma_f32_16x16x32_bf16 v[68:71], v[124:127], v[120:123], v[68:71]
    v_mfma_f32_16x16x32_bf16 v[72:75], v[128:131], v[116:119], v[72:75]
    v_mfma_f32_16x16x32_bf16 v[76:79], v[128:131], v[120:123], v[76:79]
    v_lshrrev_b32 v16, 2, v1
    v_lshlrev_b32 v16, 6, v16
    v_and_b32 v17, 3, v1
    v_lshl_add_u32 v16, v17, 3, v16
    s_mul_i32 s22, s62, 3072
    v_add_u32 v16, s22, v16
    v_and_b32 v169, 0xffff0000, v168
    v_rcp_f32 v169, v169
    v_lshlrev_b32 v168, 16, v168
    v_mul_f32 v168, v168, v169
    v_sub_f32 v168, 0, v168
    v_and_b32 v171, 0xffff0000, v170
    v_rcp_f32 v171, v171
    v_lshlrev_b32 v170, 16, v170
    v_mul_f32 v170, v170, v171
    v_sub_f32 v170, 0, v170
    v_lshlrev_b32 v200, 16, v160
    v_and_b32 v201, 0xffff0000, v160
    v_lshlrev_b32 v202, 16, v161
    v_and_b32 v203, 0xffff0000, v161
    v_lshlrev_b32 v204, 16, v162
    v_and_b32 v205, 0xffff0000, v162
    v_lshlrev_b32 v206, 16, v163
    v_and_b32 v207, 0xffff0000, v163
    s_waitcnt vmcnt(0)
    ds_read_b64_tr_b16 v[176:177], v16 offset:0
    ds_read_b64_tr_b16 v[178:179], v16 offset:32
    ds_read_b64_tr_b16 v[180:181], v16 offset:1024
    ds_read_b64_tr_b16 v[182:183], v16 offset:1056
    s_waitcnt lgkmcnt(3)
    v_lshlrev_b32 v8, 16, v136
    v_and_b32 v9, 0xffff0000, v136
    v_add_f32 v64, v64, v8
    v_add_f32 v65, v65, v9
    v_fma_f32 v8, v8, v169, v168
    v_fma_f32 v9, v9, v169, v168
    v_lshlrev_b32 v12, 16, v176
    v_and_b32 v13, 0xffff0000, v176
    v_fmac_f32 v12, v8, v200
    v_fmac_f32 v13, v9, v201
    v_add_f32 v12, v12, v64
    v_add_f32 v13, v13, v65
    v_cvt_pk_bf16_f32 v136, v12, v13
    v_lshlrev_b32 v8, 16, v137
    v_and_b32 v9, 0xffff0000, v137
    v_add_f32 v66, v66, v8
    v_add_f32 v67, v67, v9
    v_fma_f32 v8, v8, v169, v168
    v_fma_f32 v9, v9, v169, v168
    v_lshlrev_b32 v12, 16, v177
    v_and_b32 v13, 0xffff0000, v177
    v_fmac_f32 v12, v8, v202
    v_fmac_f32 v13, v9, v203
    v_add_f32 v12, v12, v66
    v_add_f32 v13, v13, v67
    v_cvt_pk_bf16_f32 v137, v12, v13
    s_mov_b32 s23, 0
    buffer_store_dwordx2 v[136:137], v14, s[32:35], s23 offen offset:0
    s_waitcnt lgkmcnt(2)
    v_lshlrev_b32 v8, 16, v138
    v_and_b32 v9, 0xffff0000, v138
    v_add_f32 v68, v68, v8
    v_add_f32 v69, v69, v9
    v_fma_f32 v8, v8, v171, v170
    v_fma_f32 v9, v9, v171, v170
    v_lshlrev_b32 v12, 16, v178
    v_and_b32 v13, 0xffff0000, v178
    v_fmac_f32 v12, v8, v200
    v_fmac_f32 v13, v9, v201
    v_add_f32 v12, v12, v68
    v_add_f32 v13, v13, v69
    v_cvt_pk_bf16_f32 v138, v12, v13
    v_lshlrev_b32 v8, 16, v139
    v_and_b32 v9, 0xffff0000, v139
    v_add_f32 v70, v70, v8
    v_add_f32 v71, v71, v9
    v_fma_f32 v8, v8, v171, v170
    v_fma_f32 v9, v9, v171, v170
    v_lshlrev_b32 v12, 16, v179
    v_and_b32 v13, 0xffff0000, v179
    v_fmac_f32 v12, v8, v202
    v_fmac_f32 v13, v9, v203
    v_add_f32 v12, v12, v70
    v_add_f32 v13, v13, v71
    v_cvt_pk_bf16_f32 v139, v12, v13
    s_mov_b32 s23, 20480
    buffer_store_dwordx2 v[138:139], v14, s[32:35], s23 offen offset:0
    s_waitcnt lgkmcnt(1)
    v_lshlrev_b32 v8, 16, v140
    v_and_b32 v9, 0xffff0000, v140
    v_add_f32 v72, v72, v8
    v_add_f32 v73, v73, v9
    v_fma_f32 v8, v8, v169, v168
    v_fma_f32 v9, v9, v169, v168
    v_lshlrev_b32 v12, 16, v180
    v_and_b32 v13, 0xffff0000, v180
    v_fmac_f32 v12, v8, v204
    v_fmac_f32 v13, v9, v205
    v_add_f32 v12, v12, v72
    v_add_f32 v13, v13, v73
    v_cvt_pk_bf16_f32 v140, v12, v13
    v_lshlrev_b32 v8, 16, v141
    v_and_b32 v9, 0xffff0000, v141
    v_add_f32 v74, v74, v8
    v_add_f32 v75, v75, v9
    v_fma_f32 v8, v8, v169, v168
    v_fma_f32 v9, v9, v169, v168
    v_lshlrev_b32 v12, 16, v181
    v_and_b32 v13, 0xffff0000, v181
    v_fmac_f32 v12, v8, v206
    v_fmac_f32 v13, v9, v207
    v_add_f32 v12, v12, v74
    v_add_f32 v13, v13, v75
    v_cvt_pk_bf16_f32 v141, v12, v13
    s_mov_b32 s23, 0
    buffer_store_dwordx2 v[140:141], v14, s[32:35], s23 offen offset:32
    s_waitcnt lgkmcnt(0)
    v_lshlrev_b32 v8, 16, v142
    v_and_b32 v9, 0xffff0000, v142
    v_add_f32 v76, v76, v8
    v_add_f32 v77, v77, v9
    v_fma_f32 v8, v8, v171, v170
    v_fma_f32 v9, v9, v171, v170
    v_lshlrev_b32 v12, 16, v182
    v_and_b32 v13, 0xffff0000, v182
    v_fmac_f32 v12, v8, v204
    v_fmac_f32 v13, v9, v205
    v_add_f32 v12, v12, v76
    v_add_f32 v13, v13, v77
    v_cvt_pk_bf16_f32 v142, v12, v13
    v_lshlrev_b32 v8, 16, v143
    v_and_b32 v9, 0xffff0000, v143
    v_add_f32 v78, v78, v8
    v_add_f32 v79, v79, v9
    v_fma_f32 v8, v8, v171, v170
    v_fma_f32 v9, v9, v171, v170
    v_lshlrev_b32 v12, 16, v183
    v_and_b32 v13, 0xffff0000, v183
    v_fmac_f32 v12, v8, v206
    v_fmac_f32 v13, v9, v207
    v_add_f32 v12, v12, v78
    v_add_f32 v13, v13, v79
    v_cvt_pk_bf16_f32 v143, v12, v13
    s_mov_b32 s23, 20480
    buffer_store_dwordx2 v[142:143], v14, s[32:35], s23 offen offset:32
g_end:
    s_branch k_end
k_c:
    s_cmp_eq_u32 s61, 3
    s_cbranch_scc0 c_cw
    s_waitcnt lgkmcnt(0)
    s_setprio 3
    v_and_b32 v1, 63, v0
    s_load_dwordx2 s[4:5], s[0:1], 0
    s_load_dwordx2 s[6:7], s[0:1], 120
    s_load_dwordx2 s[16:17], s[0:1], 112
    s_load_dwordx2 s[24:25], s[0:1], 96
    s_and_b32 s65, s3, 7
    s_lshr_b32 s66, s3, 3
    v_lshrrev_b32 v2, 3, v1
    s_lshl_b32 s20, s3, 3
    v_add_u32 v6, s20, v2
    v_mul_u32_u24 v3, 1280, v6
    v_and_b32 v4, 7, v1
    v_lshl_add_u32 v3, v4, 4, v3
    s_waitcnt lgkmcnt(0)
    s_mov_b32 s8, s4
    s_mov_b32 s9, s5
    s_mov_b32 s10, 2621440
    s_mov_b32 s11, 0x00020000
    buffer_load_dwordx4 v[8:11], v3, s[8:11], 0 offen offset:0
    buffer_load_dwordx4 v[12:15], v3, s[8:11], 0 offen offset:128
    buffer_load_dwordx4 v[16:19], v3, s[8:11], 0 offen offset:256
    buffer_load_dwordx4 v[20:23], v3, s[8:11], 0 offen offset:384
    buffer_load_dwordx4 v[24:27], v3, s[8:11], 0 offen offset:512
    buffer_load_dwordx4 v[28:31], v3, s[8:11], 0 offen offset:640
    buffer_load_dwordx4 v[32:35], v3, s[8:11], 0 offen offset:768
    buffer_load_dwordx4 v[36:39], v3, s[8:11], 0 offen offset:896
    buffer_load_dwordx4 v[40:43], v3, s[8:11], 0 offen offset:1024
    buffer_load_dwordx4 v[44:47], v3, s[8:11], 0 offen offset:1152
    v_mov_b32 v7, 0
    s_add_u32 s12, s6, 14155776
    s_addc_u32 s13, s7, 0
    s_mov_b32 s14, 32768
    s_mov_b32 s15, 0x00020000
    s_mov_b32 s52, s6
    s_mov_b32 s53, s7
    s_mov_b32 s54, 2703360
    s_mov_b32 s55, 0x00020000
    s_add_u32 s72, s6, 14680064
    s_addc_u32 s73, s7, 0
    s_mov_b32 s74, 212992
    s_mov_b32 s75, 0x00020000
    s_waitcnt vmcnt(0)
    global_load_dword v5, v7, s[16:17] sc1
    v_mov_b32 v120, 0
    v_mov_b32 v121, 0
    v_mov_b32 v122, 0
    v_mov_b32 v123, 0
    v_mov_b32 v124, 0
    v_mov_b32 v125, 0
    v_mov_b32 v126, 0
    v_mov_b32 v127, 0
    v_lshlrev_b32 v128, 16, v8
    v_and_b32 v129, 0xffff0000, v8
    v_lshlrev_b32 v130, 16, v9
    v_and_b32 v131, 0xffff0000, v9
    v_lshlrev_b32 v132, 16, v10
    v_and_b32 v133, 0xffff0000, v10
    v_lshlrev_b32 v134, 16, v11
    v_and_b32 v135, 0xffff0000, v11
    v_add_f32 v120, v120, v128
    v_add_f32 v121, v121, v129
    v_add_f32 v122, v122, v130
    v_add_f32 v123, v123, v131
    v_add_f32 v120, v120, v132
    v_add_f32 v121, v121, v133
    v_add_f32 v122, v122, v134
    v_add_f32 v123, v123, v135
    v_fmac_f32 v124, v128, v128
    v_fmac_f32 v125, v129, v129
    v_fmac_f32 v126, v130, v130
    v_fmac_f32 v127, v131, v131
    v_fmac_f32 v124, v132, v132
    v_fmac_f32 v125, v133, v133
    v_fmac_f32 v126, v134, v134
    v_fmac_f32 v127, v135, v135
    v_lshlrev_b32 v128, 16, v12
    v_and_b32 v129, 0xffff0000, v12
    v_lshlrev_b32 v130, 16, v13
    v_and_b32 v131, 0xffff0000, v13
    v_lshlrev_b32 v132, 16, v14
    v_and_b32 v133, 0xffff0000, v14
    v_lshlrev_b32 v134, 16, v15
    v_and_b32 v135, 0xffff0000, v15
    v_add_f32 v120, v120, v128
    v_add_f32 v121, v121, v129
    v_add_f32 v122, v122, v130
    v_add_f32 v123, v123, v131
    v_add_f32 v120, v120, v132
    v_add_f32 v121, v121, v133
    v_add_f32 v122, v122, v134
    v_add_f32 v123, v123, v135
    v_fmac_f32 v124, v128, v128
    v_fmac_f32 v125, v129, v129
    v_fmac_f32 v126, v130, v130
    v_fmac_f32 v127, v131, v131
    v_fmac_f32 v124, v132, v132
    v_fmac_f32 v125, v133, v133
    v_fmac_f32 v126, v134, v134
    v_fmac_f32 v127, v135, v135
    v_lshlrev_b32 v128, 16, v16
    v_and_b32 v129, 0xffff0000, v16
    v_lshlrev_b32 v130, 16, v17
    v_and_b32 v131, 0xffff0000, v17
    v_lshlrev_b32 v132, 16, v18
    v_and_b32 v133, 0xffff0000, v18
    v_lshlrev_b32 v134, 16, v19
    v_and_b32 v135, 0xffff0000, v19
    v_add_f32 v120, v120, v128
    v_add_f32 v121, v121, v129
    v_add_f32 v122, v122, v130
    v_add_f32 v123, v123, v131
    v_add_f32 v120, v120, v132
    v_add_f32 v121, v121, v133
    v_add_f32 v122, v122, v134
    v_add_f32 v123, v123, v135
    v_fmac_f32 v124, v128, v128
    v_fmac_f32 v125, v129, v129
    v_fmac_f32 v126, v130, v130
    v_fmac_f32 v127, v131, v131
    v_fmac_f32 v124, v132, v132
    v_fmac_f32 v125, v133, v133
    v_fmac_f32 v126, v134, v134
    v_fmac_f32 v127, v135, v135
    v_lshlrev_b32 v128, 16, v20
    v_and_b32 v129, 0xffff0000, v20
    v_lshlrev_b32 v130, 16, v21
    v_and_b32 v131, 0xffff0000, v21
    v_lshlrev_b32 v132, 16, v22
    v_and_b32 v133, 0xffff0000, v22
    v_lshlrev_b32 v134, 16, v23
    v_and_b32 v135, 0xffff0000, v23
    v_add_f32 v120, v120, v128
    v_add_f32 v121, v121, v129
    v_add_f32 v122, v122, v130
    v_add_f32 v123, v123, v131
    v_add_f32 v120, v120, v132
    v_add_f32 v121, v121, v133
    v_add_f32 v122, v122, v134
    v_add_f32 v123, v123, v135
    v_fmac_f32 v124, v128, v128
    v_fmac_f32 v125, v129, v129
    v_fmac_f32 v126, v130, v130
    v_fmac_f32 v127, v131, v131
    v_fmac_f32 v124, v132, v132
    v_fmac_f32 v125, v133, v133
    v_fmac_f32 v126, v134, v134
    v_fmac_f32 v127, v135, v135
    v_lshlrev_b32 v128, 16, v24
    v_and_b32 v129, 0xffff0000, v24
    v_lshlrev_b32 v130, 16, v25
    v_and_b32 v131, 0xffff0000, v25
    v_lshlrev_b32 v132, 16, v26
    v_and_b32 v133, 0xffff0000, v26
    v_lshlrev_b32 v134, 16, v27
    v_and_b32 v135, 0xffff0000, v27
    v_add_f32 v120, v120, v128
    v_add_f32 v121, v121, v129
    v_add_f32 v122, v122, v130
    v_add_f32 v123, v123, v131
    v_add_f32 v120, v120, v132
    v_add_f32 v121, v121, v133
    v_add_f32 v122, v122, v134
    v_add_f32 v123, v123, v135
    v_fmac_f32 v124, v128, v128
    v_fmac_f32 v125, v129, v129
    v_fmac_f32 v126, v130, v130
    v_fmac_f32 v127, v131, v131
    v_fmac_f32 v124, v132, v132
    v_fmac_f32 v125, v133, v133
    v_fmac_f32 v126, v134, v134
    v_fmac_f32 v127, v135, v135
    v_lshlrev_b32 v128, 16, v28
    v_and_b32 v129, 0xffff0000, v28
    v_lshlrev_b32 v130, 16, v29
    v_and_b32 v131, 0xffff0000, v29
    v_lshlrev_b32 v132, 16, v30
    v_and_b32 v133, 0xffff0000, v30
    v_lshlrev_b32 v134, 16, v31
    v_and_b32 v135, 0xffff0000, v31
    v_add_f32 v120, v120, v128
    v_add_f32 v121, v121, v129
    v_add_f32 v122, v122, v130
    v_add_f32 v123, v123, v131
    v_add_f32 v120, v120, v132
    v_add_f32 v121, v121, v133
    v_add_f32 v122, v122, v134
    v_add_f32 v123, v123, v135
    v_fmac_f32 v124, v128, v128
    v_fmac_f32 v125, v129, v129
    v_fmac_f32 v126, v130, v130
    v_fmac_f32 v127, v131, v131
    v_fmac_f32 v124, v132, v132
    v_fmac_f32 v125, v133, v133
    v_fmac_f32 v126, v134, v134
    v_fmac_f32 v127, v135, v135
    v_lshlrev_b32 v128, 16, v32
    v_and_b32 v129, 0xffff0000, v32
    v_lshlrev_b32 v130, 16, v33
    v_and_b32 v131, 0xffff0000, v33
    v_lshlrev_b32 v132, 16, v34
    v_and_b32 v133, 0xffff0000, v34
    v_lshlrev_b32 v134, 16, v35
    v_and_b32 v135, 0xffff0000, v35
    v_add_f32 v120, v120, v128
    v_add_f32 v121, v121, v129
    v_add_f32 v122, v122, v130
    v_add_f32 v123, v123, v131
    v_add_f32 v120, v120, v132
    v_add_f32 v121, v121, v133
    v_add_f32 v122, v122, v134
    v_add_f32 v123, v123, v135
    v_fmac_f32 v124, v128, v128
    v_fmac_f32 v125, v129, v129
    v_fmac_f32 v126, v130, v130
    v_fmac_f32 v127, v131, v131
    v_fmac_f32 v124, v132, v132
    v_fmac_f32 v125, v133, v133
    v_fmac_f32 v126, v134, v134
    v_fmac_f32 v127, v135, v135
    v_lshlrev_b32 v128, 16, v36
    v_and_b32 v129, 0xffff0000, v36
    v_lshlrev_b32 v130, 16, v37
    v_and_b32 v131, 0xffff0000, v37
    v_lshlrev_b32 v132, 16, v38
    v_and_b32 v133, 0xffff0000, v38
    v_lshlrev_b32 v134, 16, v39
    v_and_b32 v135, 0xffff0000, v39
    v_add_f32 v120, v120, v128
    v_add_f32 v121, v121, v129
    v_add_f32 v122, v122, v130
    v_add_f32 v123, v123, v131
    v_add_f32 v120, v120, v132
    v_add_f32 v121, v121, v133
    v_add_f32 v122, v122, v134
    v_add_f32 v123, v123, v135
    v_fmac_f32 v124, v128, v128
    v_fmac_f32 v125, v129, v129
    v_fmac_f32 v126, v130, v130
    v_fmac_f32 v127, v131, v131
    v_fmac_f32 v124, v132, v132
    v_fmac_f32 v125, v133, v133
    v_fmac_f32 v126, v134, v134
    v_fmac_f32 v127, v135, v135
    v_lshlrev_b32 v128, 16, v40
    v_and_b32 v129, 0xffff0000, v40
    v_lshlrev_b32 v130, 16, v41
    v_and_b32 v131, 0xffff0000, v41
    v_lshlrev_b32 v132, 16, v42
    v_and_b32 v133, 0xffff0000, v42
    v_lshlrev_b32 v134, 16, v43
    v_and_b32 v135, 0xffff0000, v43
    v_add_f32 v120, v120, v128
    v_add_f32 v121, v121, v129
    v_add_f32 v122, v122, v130
    v_add_f32 v123, v123, v131
    v_add_f32 v120, v120, v132
    v_add_f32 v121, v121, v133
    v_add_f32 v122, v122, v134
    v_add_f32 v123, v123, v135
    v_fmac_f32 v124, v128, v128
    v_fmac_f32 v125, v129, v129
    v_fmac_f32 v126, v130, v130
    v_fmac_f32 v127, v131, v131
    v_fmac_f32 v124, v132, v132
    v_fmac_f32 v125, v133, v133
    v_fmac_f32 v126, v134, v134
    v_fmac_f32 v127, v135, v135
    v_lshlrev_b32 v128, 16, v44
    v_and_b32 v129, 0xffff0000, v44
    v_lshlrev_b32 v130, 16, v45
    v_and_b32 v131, 0xffff0000, v45
    v_lshlrev_b32 v132, 16, v46
    v_and_b32 v133, 0xffff0000, v46
    v_lshlrev_b32 v134, 16, v47
    v_and_b32 v135, 0xffff0000, v47
    v_add_f32 v120, v120, v128
    v_add_f32 v121, v121, v129
    v_add_f32 v122, v122, v130
    v_add_f32 v123, v123, v131
    v_add_f32 v120, v120, v132
    v_add_f32 v121, v121, v133
    v_add_f32 v122, v122, v134
    v_add_f32 v123, v123, v135
    v_fmac_f32 v124, v128, v128
    v_fmac_f32 v125, v129, v129
    v_fmac_f32 v126, v130, v130
    v_fmac_f32 v127, v131, v131
    v_fmac_f32 v124, v132, v132
    v_fmac_f32 v125, v133, v133
    v_fmac_f32 v126, v134, v134
    v_fmac_f32 v127, v135, v135
    v_add_f32 v120, v120, v121
    v_add_f32 v124, v124, v125
    v_add_f32 v122, v122, v123
    v_add_f32 v126, v126, v127
    v_add_f32 v120, v120, v122
    v_add_f32 v124, v124, v126
    s_nop 0
    v_add_f32_dpp v120, v120, v120 quad_perm:[1,0,3,2] row_mask:0xf bank_mask:0xf
    s_nop 1
    v_add_f32_dpp v120, v120, v120 quad_perm:[2,3,0,1] row_mask:0xf bank_mask:0xf
    s_nop 1
    v_add_f32_dpp v120, v120, v120 row_half_mirror row_mask:0xf bank_mask:0xf
    v_add_f32_dpp v124, v124, v124 quad_perm:[1,0,3,2] row_mask:0xf bank_mask:0xf
    s_nop 1
    v_add_f32_dpp v124, v124, v124 quad_perm:[2,3,0,1] row_mask:0xf bank_mask:0xf
    s_nop 1
    v_add_f32_dpp v124, v124, v124 row_half_mirror row_mask:0xf bank_mask:0xf
    v_mul_f32 v120, 0x3acccccd, v120
    v_mul_f32 v124, 0x3acccccd, v124
    v_fma_f32 v124, -v120, v120, v124
    v_max_f32 v124, 0, v124
    v_cvt_pk_bf16_f32 v124, v124, v124
    v_lshlrev_b32 v124, 16, v124
    v_add_f32 v124, 0x3727c5ac, v124
    v_cvt_pk_bf16_f32 v124, v124, v124
    v_lshlrev_b32 v124, 16, v124
    v_sqrt_f32 v124, v124
    s_nop 0
    v_cvt_pk_bf16_f32 v126, v120, v124
    s_waitcnt vmcnt(0)
    v_readfirstlane_b32 s70, v5
    s_nop 2
    s_cmp_eq_u32 s70, 0
    s_cbranch_scc0 cL_nok
    s_load_dwordx2 s[20:21], s[0:1], 112
    v_mov_b32 v129, 0
    s_mov_b32 s22, 4096
    s_waitcnt lgkmcnt(0)
cL_n0_nl:
    global_load_dword v128, v129, s[20:21] sc1
    s_waitcnt vmcnt(0)
    v_readfirstlane_b32 s70, v128
    s_sub_u32 s22, s22, 1
    s_cmp_eq_u32 s22, 0
    s_cbranch_scc1 cL_n0_nd
    s_cmp_eq_u32 s70, 0
    s_cbranch_scc0 cL_n0_nd
    s_sleep 4
    s_branch cL_n0_nl
cL_n0_nd:
cL_nok:
    v_mov_b32 v127, s70
    v_and_b32 v2, 7, v6
    v_lshrrev_b32 v6, 3, v6
    v_lshlrev_b32 v6, 7, v6
    v_lshl_add_u32 v6, v2, 3, v6
    s_mov_b32 exec_lo, 0x01010101
    s_mov_b32 exec_hi, 0x01010101
    buffer_store_dwordx2 v[126:127], v6, s[12:15], 0 offen sc1
    s_mov_b64 exec, -1
    s_mov_b32 s22, 0x1999999a
    s_lshl_b32 s20, s66, 6
    s_mul_i32 s21, s65, 160
    v_add_u32 v120, 0, v1
    v_mul_hi_u32 v108, v120, s22
    v_mul_u32_u24 v121, 10, v108
    v_sub_u32 v121, v120, v121
    v_add_u32 v108, s20, v108
    v_mul_u32_u24 v120, 1280, v108
    v_lshl_add_u32 v208, v121, 4, v120
    buffer_load_dwordx4 v[48:51], v208, s[8:11], s21 offen
    v_add_u32 v120, 64, v1
    v_mul_hi_u32 v109, v120, s22
    v_mul_u32_u24 v121, 10, v109
    v_sub_u32 v121, v120, v121
    v_add_u32 v109, s20, v109
    v_mul_u32_u24 v120, 1280, v109
    v_lshl_add_u32 v209, v121, 4, v120
    buffer_load_dwordx4 v[52:55], v209, s[8:11], s21 offen
    v_add_u32 v120, 128, v1
    v_mul_hi_u32 v110, v120, s22
    v_mul_u32_u24 v121, 10, v110
    v_sub_u32 v121, v120, v121
    v_add_u32 v110, s20, v110
    v_mul_u32_u24 v120, 1280, v110
    v_lshl_add_u32 v210, v121, 4, v120
    buffer_load_dwordx4 v[56:59], v210, s[8:11], s21 offen
    v_add_u32 v120, 192, v1
    v_mul_hi_u32 v111, v120, s22
    v_mul_u32_u24 v121, 10, v111
    v_sub_u32 v121, v120, v121
    v_add_u32 v111, s20, v111
    v_mul_u32_u24 v120, 1280, v111
    v_lshl_add_u32 v211, v121, 4, v120
    buffer_load_dwordx4 v[60:63], v211, s[8:11], s21 offen
    v_add_u32 v120, 256, v1
    v_mul_hi_u32 v112, v120, s22
    v_mul_u32_u24 v121, 10, v112
    v_sub_u32 v121, v120, v121
    v_add_u32 v112, s20, v112
    v_mul_u32_u24 v120, 1280, v112
    v_lshl_add_u32 v212, v121, 4, v120
    buffer_load_dwordx4 v[64:67], v212, s[8:11], s21 offen
    v_add_u32 v120, 320, v1
    v_mul_hi_u32 v113, v120, s22
    v_mul_u32_u24 v121, 10, v113
    v_sub_u32 v121, v120, v121
    v_add_u32 v113, s20, v113
    v_mul_u32_u24 v120, 1280, v113
    v_lshl_add_u32 v213, v121, 4, v120
    buffer_load_dwordx4 v[68:71], v213, s[8:11], s21 offen
    v_add_u32 v120, 384, v1
    v_mul_hi_u32 v114, v120, s22
    v_mul_u32_u24 v121, 10, v114
    v_sub_u32 v121, v120, v121
    v_add_u32 v114, s20, v114
    v_mul_u32_u24 v120, 1280, v114
    v_lshl_add_u32 v214, v121, 4, v120
    buffer_load_dwordx4 v[72:75], v214, s[8:11], s21 offen
    v_add_u32 v120, 448, v1
    v_mul_hi_u32 v115, v120, s22
    v_mul_u32_u24 v121, 10, v115
    v_sub_u32 v121, v120, v121
    v_add_u32 v115, s20, v115
    v_mul_u32_u24 v120, 1280, v115
    v_lshl_add_u32 v215, v121, 4, v120
    buffer_load_dwordx4 v[76:79], v215, s[8:11], s21 offen
    v_add_u32 v120, 512, v1
    v_mul_hi_u32 v116, v120, s22
    v_mul_u32_u24 v121, 10, v116
    v_sub_u32 v121, v120, v121
    v_add_u32 v116, s20, v116
    v_mul_u32_u24 v120, 1280, v116
    v_lshl_add_u32 v216, v121, 4, v120
    buffer_load_dwordx4 v[80:83], v216, s[8:11], s21 offen
    v_add_u32 v120, 576, v1
    v_mul_hi_u32 v117, v120, s22
    v_mul_u32_u24 v121, 10, v117
    v_sub_u32 v121, v120, v121
    v_add_u32 v117, s20, v117
    v_mul_u32_u24 v120, 1280, v117
    v_lshl_add_u32 v217, v121, 4, v120
    buffer_load_dwordx4 v[84:87], v217, s[8:11], s21 offen
    v_and_b32 v2, 7, v108
    v_lshrrev_b32 v108, 3, v108
    v_lshlrev_b32 v108, 7, v108
    v_lshl_add_u32 v108, v2, 3, v108
    v_and_b32 v2, 7, v109
    v_lshrrev_b32 v109, 3, v109
    v_lshlrev_b32 v109, 7, v109
    v_lshl_add_u32 v109, v2, 3, v109
    v_and_b32 v2, 7, v110
    v_lshrrev_b32 v110, 3, v110
    v_lshlrev_b32 v110, 7, v110
    v_lshl_add_u32 v110, v2, 3, v110
    v_and_b32 v2, 7, v111
    v_lshrrev_b32 v111, 3, v111
    v_lshlrev_b32 v111, 7, v111
    v_lshl_add_u32 v111, v2, 3, v111
    v_and_b32 v2, 7, v112
    v_lshrrev_b32 v112, 3, v112
    v_lshlrev_b32 v112, 7, v112
    v_lshl_add_u32 v112, v2, 3, v112
    v_and_b32 v2, 7, v113
    v_lshrrev_b32 v113, 3, v113
    v_lshlrev_b32 v113, 7, v113
    v_lshl_add_u32 v113, v2, 3, v113
    v_and_b32 v2, 7, v114
    v_lshrrev_b32 v114, 3, v114
    v_lshlrev_b32 v114, 7, v114
    v_lshl_add_u32 v114, v2, 3, v114
    v_and_b32 v2, 7, v115
    v_lshrrev_b32 v115, 3, v115
    v_lshlrev_b32 v115, 7, v115
    v_lshl_add_u32 v115, v2, 3, v115
    v_and_b32 v2, 7, v116
    v_lshrrev_b32 v116, 3, v116
    v_lshlrev_b32 v116, 7, v116
    v_lshl_add_u32 v116, v2, 3, v116
    v_and_b32 v2, 7, v117
    v_lshrrev_b32 v117, 3, v117
    v_lshlrev_b32 v117, 7, v117
    v_lshl_add_u32 v117, v2, 3, v117
    s_mov_b32 s20, 4096
cL_sl:
    buffer_load_dwordx2 v[88:89], v108, s[12:15], 0 offen sc1
    buffer_load_dwordx2 v[90:91], v109, s[12:15], 0 offen sc1
    buffer_load_dwordx2 v[92:93], v110, s[12:15], 0 offen sc1
    buffer_load_dwordx2 v[94:95], v111, s[12:15], 0 offen sc1
    buffer_load_dwordx2 v[96:97], v112, s[12:15], 0 offen sc1
    buffer_load_dwordx2 v[98:99], v113, s[12:15], 0 offen sc1
    buffer_load_dwordx2 v[100:101], v114, s[12:15], 0 offen sc1
    buffer_load_dwordx2 v[102:103], v115, s[12:15], 0 offen sc1
    buffer_load_dwordx2 v[104:105], v116, s[12:15], 0 offen sc1
    buffer_load_dwordx2 v[106:107], v117, s[12:15], 0 offen sc1
    s_waitcnt vmcnt(0)
    v_xor_b32 v2, s70, v89
    v_xor_b32 v4, s70, v91
    v_or_b32 v2, v2, v4
    v_xor_b32 v4, s70, v93
    v_or_b32 v2, v2, v4
    v_xor_b32 v4, s70, v95
    v_or_b32 v2, v2, v4
    v_xor_b32 v4, s70, v97
    v_or_b32 v2, v2, v4
    v_xor_b32 v4, s70, v99
    v_or_b32 v2, v2, v4
    v_xor_b32 v4, s70, v101
    v_or_b32 v2, v2, v4
    v_xor_b32 v4, s70, v103
    v_or_b32 v2, v2, v4
    v_xor_b32 v4, s70, v105
    v_or_b32 v2, v2, v4
    v_xor_b32 v4, s70, v107
    v_or_b32 v2, v2, v4
    v_cmp_ne_u32 vcc, 0, v2
    s_sub_u32 s20, s20, 1
    s_cmp_eq_u32 s20, 0
    s_cbranch_scc1 cL_sd
    s_nop 1
    s_cbranch_vccz cL_sd
    s_sleep 4
    s_branch cL_sl
cL_sd:
    s_mov_b32 s28, s24
    s_mov_b32 s29, s25
    s_mov_b32 s30, 1966080
    s_mov_b32 s31, 0x00020000
    s_mul_i32 s21, s65, 160
    buffer_load_dwordx4 v[144:147], v208, s[28:31], s21 offen
    buffer_load_dwordx4 v[148:151], v209, s[28:31], s21 offen
    buffer_load_dwordx4 v[152:155], v210, s[28:31], s21 offen
    buffer_load_dwordx4 v[156:159], v211, s[28:31], s21 offen
    buffer_load_dwordx4 v[160:163], v212, s[28:31], s21 offen
    buffer_load_dwordx4 v[164:167], v213, s[28:31], s21 offen
    buffer_load_dwordx4 v[168:171], v214, s[28:31], s21 offen
    buffer_load_dwordx4 v[172:175], v215, s[28:31], s21 offen
    buffer_load_dwordx4 v[176:179], v216, s[28:31], s21 offen
    buffer_load_dwordx4 v[180:183], v217, s[28:31], s21 offen
    v_lshlrev_b32 v2, 4, v1
    v_add_u32 v2, 69632, v2
    v_and_b32 v89, 0xffff0000, v88
    v_rcp_f32 v89, v89
    v_lshlrev_b32 v88, 16, v88
    v_mul_f32 v88, v88, v89
    v_lshlrev_b32 v120, 16, v48
    v_and_b32 v121, 0xffff0000, v48
    v_fma_f32 v120, v120, v89, -v88
    v_fma_f32 v121, v121, v89, -v88
    v_cvt_pk_bf16_f32 v48, v120, v121
    v_lshlrev_b32 v120, 16, v49
    v_and_b32 v121, 0xffff0000, v49
    v_fma_f32 v120, v120, v89, -v88
    v_fma_f32 v121, v121, v89, -v88
    v_cvt_pk_bf16_f32 v49, v120, v121
    v_lshlrev_b32 v120, 16, v50
    v_and_b32 v121, 0xffff0000, v50
    v_fma_f32 v120, v120, v89, -v88
    v_fma_f32 v121, v121, v89, -v88
    v_cvt_pk_bf16_f32 v50, v120, v121
    v_lshlrev_b32 v120, 16, v51
    v_and_b32 v121, 0xffff0000, v51
    v_fma_f32 v120, v120, v89, -v88
    v_fma_f32 v121, v121, v89, -v88
    v_cvt_pk_bf16_f32 v51, v120, v121
    ds_write_b128 v2, v[48:51] offset:0
    v_and_b32 v91, 0xffff0000, v90
    v_rcp_f32 v91, v91
    v_lshlrev_b32 v90, 16, v90
    v_mul_f32 v90, v90, v91
    v_lshlrev_b32 v120, 16, v52
    v_and_b32 v121, 0xffff0000, v52
    v_fma_f32 v120, v120, v91, -v90
    v_fma_f32 v121, v121, v91, -v90
    v_cvt_pk_bf16_f32 v52, v120, v121
    v_lshlrev_b32 v120, 16, v53
    v_and_b32 v121, 0xffff0000, v53
    v_fma_f32 v120, v120, v91, -v90
    v_fma_f32 v121, v121, v91, -v90
    v_cvt_pk_bf16_f32 v53, v120, v121
    v_lshlrev_b32 v120, 16, v54
    v_and_b32 v121, 0xffff0000, v54
    v_fma_f32 v120, v120, v91, -v90
    v_fma_f32 v121, v121, v91, -v90
    v_cvt_pk_bf16_f32 v54, v120, v121
    v_lshlrev_b32 v120, 16, v55
    v_and_b32 v121, 0xffff0000, v55
    v_fma_f32 v120, v120, v91, -v90
    v_fma_f32 v121, v121, v91, -v90
    v_cvt_pk_bf16_f32 v55, v120, v121
    ds_write_b128 v2, v[52:55] offset:1024
    v_and_b32 v93, 0xffff0000, v92
    v_rcp_f32 v93, v93
    v_lshlrev_b32 v92, 16, v92
    v_mul_f32 v92, v92, v93
    v_lshlrev_b32 v120, 16, v56
    v_and_b32 v121, 0xffff0000, v56
    v_fma_f32 v120, v120, v93, -v92
    v_fma_f32 v121, v121, v93, -v92
    v_cvt_pk_bf16_f32 v56, v120, v121
    v_lshlrev_b32 v120, 16, v57
    v_and_b32 v121, 0xffff0000, v57
    v_fma_f32 v120, v120, v93, -v92
    v_fma_f32 v121, v121, v93, -v92
    v_cvt_pk_bf16_f32 v57, v120, v121
    v_lshlrev_b32 v120, 16, v58
    v_and_b32 v121, 0xffff0000, v58
    v_fma_f32 v120, v120, v93, -v92
    v_fma_f32 v121, v121, v93, -v92
    v_cvt_pk_bf16_f32 v58, v120, v121
    v_lshlrev_b32 v120, 16, v59
    v_and_b32 v121, 0xffff0000, v59
    v_fma_f32 v120, v120, v93, -v92
    v_fma_f32 v121, v121, v93, -v92
    v_cvt_pk_bf16_f32 v59, v120, v121
    ds_write_b128 v2, v[56:59] offset:2048
    v_and_b32 v95, 0xffff0000, v94
    v_rcp_f32 v95, v95
    v_lshlrev_b32 v94, 16, v94
    v_mul_f32 v94, v94, v95
    v_lshlrev_b32 v120, 16, v60
    v_and_b32 v121, 0xffff0000, v60
    v_fma_f32 v120, v120, v95, -v94
    v_fma_f32 v121, v121, v95, -v94
    v_cvt_pk_bf16_f32 v60, v120, v121
    v_lshlrev_b32 v120, 16, v61
    v_and_b32 v121, 0xffff0000, v61
    v_fma_f32 v120, v120, v95, -v94
    v_fma_f32 v121, v121, v95, -v94
    v_cvt_pk_bf16_f32 v61, v120, v121
    v_lshlrev_b32 v120, 16, v62
    v_and_b32 v121, 0xffff0000, v62
    v_fma_f32 v120, v120, v95, -v94
    v_fma_f32 v121, v121, v95, -v94
    v_cvt_pk_bf16_f32 v62, v120, v121
    v_lshlrev_b32 v120, 16, v63
    v_and_b32 v121, 0xffff0000, v63
    v_fma_f32 v120, v120, v95, -v94
    v_fma_f32 v121, v121, v95, -v94
    v_cvt_pk_bf16_f32 v63, v120, v121
    ds_write_b128 v2, v[60:63] offset:3072
    v_and_b32 v97, 0xffff0000, v96
    v_rcp_f32 v97, v97
    v_lshlrev_b32 v96, 16, v96
    v_mul_f32 v96, v96, v97
    v_lshlrev_b32 v120, 16, v64
    v_and_b32 v121, 0xffff0000, v64
    v_fma_f32 v120, v120, v97, -v96
    v_fma_f32 v121, v121, v97, -v96
    v_cvt_pk_bf16_f32 v64, v120, v121
    v_lshlrev_b32 v120, 16, v65
    v_and_b32 v121, 0xffff0000, v65
    v_fma_f32 v120, v120, v97, -v96
    v_fma_f32 v121, v121, v97, -v96
    v_cvt_pk_bf16_f32 v65, v120, v121
    v_lshlrev_b32 v120, 16, v66
    v_and_b32 v121, 0xffff0000, v66
    v_fma_f32 v120, v120, v97, -v96
    v_fma_f32 v121, v121, v97, -v96
    v_cvt_pk_bf16_f32 v66, v120, v121
    v_lshlrev_b32 v120, 16, v67
    v_and_b32 v121, 0xffff0000, v67
    v_fma_f32 v120, v120, v97, -v96
    v_fma_f32 v121, v121, v97, -v96
    v_cvt_pk_bf16_f32 v67, v120, v121
    ds_write_b128 v2, v[64:67] offset:4096
    v_and_b32 v99, 0xffff0000, v98
    v_rcp_f32 v99, v99
    v_lshlrev_b32 v98, 16, v98
    v_mul_f32 v98, v98, v99
    v_lshlrev_b32 v120, 16, v68
    v_and_b32 v121, 0xffff0000, v68
    v_fma_f32 v120, v120, v99, -v98
    v_fma_f32 v121, v121, v99, -v98
    v_cvt_pk_bf16_f32 v68, v120, v121
    v_lshlrev_b32 v120, 16, v69
    v_and_b32 v121, 0xffff0000, v69
    v_fma_f32 v120, v120, v99, -v98
    v_fma_f32 v121, v121, v99, -v98
    v_cvt_pk_bf16_f32 v69, v120, v121
    v_lshlrev_b32 v120, 16, v70
    v_and_b32 v121, 0xffff0000, v70
    v_fma_f32 v120, v120, v99, -v98
    v_fma_f32 v121, v121, v99, -v98
    v_cvt_pk_bf16_f32 v70, v120, v121
    v_lshlrev_b32 v120, 16, v71
    v_and_b32 v121, 0xffff0000, v71
    v_fma_f32 v120, v120, v99, -v98
    v_fma_f32 v121, v121, v99, -v98
    v_cvt_pk_bf16_f32 v71, v120, v121
    ds_write_b128 v2, v[68:71] offset:5120
    v_and_b32 v101, 0xffff0000, v100
    v_rcp_f32 v101, v101
    v_lshlrev_b32 v100, 16, v100
    v_mul_f32 v100, v100, v101
    v_lshlrev_b32 v120, 16, v72
    v_and_b32 v121, 0xffff0000, v72
    v_fma_f32 v120, v120, v101, -v100
    v_fma_f32 v121, v121, v101, -v100
    v_cvt_pk_bf16_f32 v72, v120, v121
    v_lshlrev_b32 v120, 16, v73
    v_and_b32 v121, 0xffff0000, v73
    v_fma_f32 v120, v120, v101, -v100
    v_fma_f32 v121, v121, v101, -v100
    v_cvt_pk_bf16_f32 v73, v120, v121
    v_lshlrev_b32 v120, 16, v74
    v_and_b32 v121, 0xffff0000, v74
    v_fma_f32 v120, v120, v101, -v100
    v_fma_f32 v121, v121, v101, -v100
    v_cvt_pk_bf16_f32 v74, v120, v121
    v_lshlrev_b32 v120, 16, v75
    v_and_b32 v121, 0xffff0000, v75
    v_fma_f32 v120, v120, v101, -v100
    v_fma_f32 v121, v121, v101, -v100
    v_cvt_pk_bf16_f32 v75, v120, v121
    ds_write_b128 v2, v[72:75] offset:6144
    v_and_b32 v103, 0xffff0000, v102
    v_rcp_f32 v103, v103
    v_lshlrev_b32 v102, 16, v102
    v_mul_f32 v102, v102, v103
    v_lshlrev_b32 v120, 16, v76
    v_and_b32 v121, 0xffff0000, v76
    v_fma_f32 v120, v120, v103, -v102
    v_fma_f32 v121, v121, v103, -v102
    v_cvt_pk_bf16_f32 v76, v120, v121
    v_lshlrev_b32 v120, 16, v77
    v_and_b32 v121, 0xffff0000, v77
    v_fma_f32 v120, v120, v103, -v102
    v_fma_f32 v121, v121, v103, -v102
    v_cvt_pk_bf16_f32 v77, v120, v121
    v_lshlrev_b32 v120, 16, v78
    v_and_b32 v121, 0xffff0000, v78
    v_fma_f32 v120, v120, v103, -v102
    v_fma_f32 v121, v121, v103, -v102
    v_cvt_pk_bf16_f32 v78, v120, v121
    v_lshlrev_b32 v120, 16, v79
    v_and_b32 v121, 0xffff0000, v79
    v_fma_f32 v120, v120, v103, -v102
    v_fma_f32 v121, v121, v103, -v102
    v_cvt_pk_bf16_f32 v79, v120, v121
    ds_write_b128 v2, v[76:79] offset:7168
    v_and_b32 v105, 0xffff0000, v104
    v_rcp_f32 v105, v105
    v_lshlrev_b32 v104, 16, v104
    v_mul_f32 v104, v104, v105
    v_lshlrev_b32 v120, 16, v80
    v_and_b32 v121, 0xffff0000, v80
    v_fma_f32 v120, v120, v105, -v104
    v_fma_f32 v121, v121, v105, -v104
    v_cvt_pk_bf16_f32 v80, v120, v121
    v_lshlrev_b32 v120, 16, v81
    v_and_b32 v121, 0xffff0000, v81
    v_fma_f32 v120, v120, v105, -v104
    v_fma_f32 v121, v121, v105, -v104
    v_cvt_pk_bf16_f32 v81, v120, v121
    v_lshlrev_b32 v120, 16, v82
    v_and_b32 v121, 0xffff0000, v82
    v_fma_f32 v120, v120, v105, -v104
    v_fma_f32 v121, v121, v105, -v104
    v_cvt_pk_bf16_f32 v82, v120, v121
    v_lshlrev_b32 v120, 16, v83
    v_and_b32 v121, 0xffff0000, v83
    v_fma_f32 v120, v120, v105, -v104
    v_fma_f32 v121, v121, v105, -v104
    v_cvt_pk_bf16_f32 v83, v120, v121
    ds_write_b128 v2, v[80:83] offset:8192
    v_and_b32 v107, 0xffff0000, v106
    v_rcp_f32 v107, v107
    v_lshlrev_b32 v106, 16, v106
    v_mul_f32 v106, v106, v107
    v_lshlrev_b32 v120, 16, v84
    v_and_b32 v121, 0xffff0000, v84
    v_fma_f32 v120, v120, v107, -v106
    v_fma_f32 v121, v121, v107, -v106
    v_cvt_pk_bf16_f32 v84, v120, v121
    v_lshlrev_b32 v120, 16, v85
    v_and_b32 v121, 0xffff0000, v85
    v_fma_f32 v120, v120, v107, -v106
    v_fma_f32 v121, v121, v107, -v106
    v_cvt_pk_bf16_f32 v85, v120, v121
    v_lshlrev_b32 v120, 16, v86
    v_and_b32 v121, 0xffff0000, v86
    v_fma_f32 v120, v120, v107, -v106
    v_fma_f32 v121, v121, v107, -v106
    v_cvt_pk_bf16_f32 v86, v120, v121
    v_lshlrev_b32 v120, 16, v87
    v_and_b32 v121, 0xffff0000, v87
    v_fma_f32 v120, v120, v107, -v106
    v_fma_f32 v121, v121, v107, -v106
    v_cvt_pk_bf16_f32 v87, v120, v121
    ds_write_b128 v2, v[84:87] offset:9216
    v_lshrrev_b32 v2, 4, v1
    v_lshlrev_b32 v3, 3, v2
    v_bfe_u32 v4, v1, 2, 2
    v_add_u32 v3, v3, v4
    v_mul_u32_u24 v3, 160, v3
    v_and_b32 v4, 3, v1
    v_lshl_add_u32 v3, v4, 3, v3
    v_add_u32 v3, 69632, v3
    v_and_b32 v4, 15, v1
    s_mul_i32 s20, s65, 80
    v_add_u32 v4, s20, v4
    v_mul_u32_u24 v4, 4224, v4
    v_lshl_add_u32 v4, v2, 4, v4
    s_lshl_b32 s21, s66, 7
    v_add_u32 v4, s21, v4
    s_waitcnt lgkmcnt(0)
    ds_read_b64_tr_b16 v[8:9], v3 offset:0
    ds_read_b64_tr_b16 v[10:11], v3 offset:640
    ds_read_b64_tr_b16 v[12:13], v3 offset:5120
    ds_read_b64_tr_b16 v[14:15], v3 offset:5760
    ds_read_b64_tr_b16 v[16:17], v3 offset:32
    ds_read_b64_tr_b16 v[18:19], v3 offset:672
    ds_read_b64_tr_b16 v[20:21], v3 offset:5152
    ds_read_b64_tr_b16 v[22:23], v3 offset:5792
    s_waitcnt lgkmcnt(0)
    ds_read_b64_tr_b16 v[24:25], v3 offset:64
    ds_read_b64_tr_b16 v[26:27], v3 offset:704
    ds_read_b64_tr_b16 v[28:29], v3 offset:5184
    ds_read_b64_tr_b16 v[30:31], v3 offset:5824
    ds_read_b64_tr_b16 v[32:33], v3 offset:96
    ds_read_b64_tr_b16 v[34:35], v3 offset:736
    ds_read_b64_tr_b16 v[36:37], v3 offset:5216
    ds_read_b64_tr_b16 v[38:39], v3 offset:5856
    s_waitcnt lgkmcnt(0)
    ds_read_b64_tr_b16 v[40:41], v3 offset:128
    ds_read_b64_tr_b16 v[42:43], v3 offset:768
    ds_read_b64_tr_b16 v[44:45], v3 offset:5248
    ds_read_b64_tr_b16 v[46:47], v3 offset:5888
    s_waitcnt lgkmcnt(0)
    s_mov_b32 s20, 0
    buffer_store_dwordx4 v[8:11], v4, s[52:55], s20 offen sc1
    s_mov_b32 s20, 64
    buffer_store_dwordx4 v[12:15], v4, s[52:55], s20 offen sc1
    s_mov_b32 s20, 67584
    buffer_store_dwordx4 v[16:19], v4, s[52:55], s20 offen sc1
    s_mov_b32 s20, 67648
    buffer_store_dwordx4 v[20:23], v4, s[52:55], s20 offen sc1
    s_mov_b32 s20, 135168
    buffer_store_dwordx4 v[24:27], v4, s[52:55], s20 offen sc1
    s_mov_b32 s20, 135232
    buffer_store_dwordx4 v[28:31], v4, s[52:55], s20 offen sc1
    s_mov_b32 s20, 202752
    buffer_store_dwordx4 v[32:35], v4, s[52:55], s20 offen sc1
    s_mov_b32 s20, 202816
    buffer_store_dwordx4 v[36:39], v4, s[52:55], s20 offen sc1
    s_mov_b32 s20, 270336
    buffer_store_dwordx4 v[40:43], v4, s[52:55], s20 offen sc1
    s_mov_b32 s20, 270400
    buffer_store_dwordx4 v[44:47], v4, s[52:55], s20 offen sc1
    s_waitcnt vmcnt(0)
    s_lshl_b32 s20, s65, 5
    s_add_u32 s20, s20, s66
    s_lshl_b32 s20, s20, 7
    v_mov_b32 v120, s70
    v_mov_b32 v121, 0
    s_mov_b64 exec, 1
    buffer_store_dword v120, v121, s[72:75], s20 offen sc1
    s_mov_b64 exec, -1
    s_cmp_ge_u32 s66, 24
    s_cbranch_scc1 cL_norp
    s_add_u32 s28, s6, 5898240
    s_addc_u32 s29, s7, 0
    s_mov_b32 s30, 1966080
    s_mov_b32 s31, 0x00020000
    s_mul_i32 s20, s65, 245760
    s_mul_i32 s21, s66, 10240
    s_add_u32 s20, s20, s21
    v_lshlrev_b32 v2, 4, v1
    buffer_store_dwordx4 v[144:147], v2, s[28:31], s20 offen offset:0 sc1
    buffer_store_dwordx4 v[148:151], v2, s[28:31], s20 offen offset:1024 sc1
    buffer_store_dwordx4 v[152:155], v2, s[28:31], s20 offen offset:2048 sc1
    buffer_store_dwordx4 v[156:159], v2, s[28:31], s20 offen offset:3072 sc1
    v_add_u32 v2, 4096, v2
    buffer_store_dwordx4 v[160:163], v2, s[28:31], s20 offen offset:0 sc1
    buffer_store_dwordx4 v[164:167], v2, s[28:31], s20 offen offset:1024 sc1
    buffer_store_dwordx4 v[168:171], v2, s[28:31], s20 offen offset:2048 sc1
    buffer_store_dwordx4 v[172:175], v2, s[28:31], s20 offen offset:3072 sc1
    v_add_u32 v2, 4096, v2
    buffer_store_dwordx4 v[176:179], v2, s[28:31], s20 offen offset:0 sc1
    buffer_store_dwordx4 v[180:183], v2, s[28:31], s20 offen offset:1024 sc1
    s_waitcnt vmcnt(0)
    s_lshl_b32 s20, s3, 7
    s_add_u32 s20, s20, 180224
    v_mov_b32 v120, s70
    v_mov_b32 v121, 0
    s_mov_b64 exec, 1
    buffer_store_dword v120, v121, s[72:75], s20 offen sc1
    s_mov_b64 exec, -1
cL_norp:
    s_branch c_end
c_cw:
    s_cmp_ge_u32 s61, s62
    s_cbranch_scc0 c_act
    s_waitcnt lgkmcnt(0)
    v_and_b32 v1, 63, v0
    s_load_dwordx2 s[4:5], s[0:1], 0
    s_load_dwordx2 s[12:13], s[0:1], 80
    s_load_dwordx2 s[14:15], s[0:1], 88
    s_lshr_b32 s67, s66, 1
    s_lshl_b32 s20, s67, 13
    v_lshlrev_b32 v2, 7, v1
    v_add_u32 v2, s20, v2
    s_mov_b32 s21, k_end-k_start
    v_min_u32 v2, s21, v2
    global_load_dword v10, v2, s[98:99]
    s_waitcnt lgkmcnt(0)
    s_cmp_ge_u32 s67, 12
    s_cbranch_scc1 cP_x
    s_cmp_ge_u32 s67, 6
    s_cselect_b32 s8, s14, s12
    s_cselect_b32 s9, s15, s13
    s_cselect_b32 s20, 6, 0
    s_mov_b32 s10, 1966080
    s_mov_b32 s11, 0x00020000
    s_sub_u32 s20, s67, s20
    s_lshl_b32 s20, s20, 7
    s_mov_b32 s22, 0x15555556
    s_and_b32 s23, s65, 1
    s_mul_i32 s23, s23, 1536
    v_add_u32 v2, s20, v1
    v_mul_hi_u32 v3, v2, s22
    v_mul_u32_u24 v4, 12, v3
    v_sub_u32 v4, v2, v4
    v_mul_u32_u24 v3, 3072, v3
    v_lshl_add_u32 v3, v4, 7, v3
    v_add_u32 v6, s23, v3
    v_add_u32 v2, s20, v1
    v_add_u32 v2, 64, v2
    v_mul_hi_u32 v3, v2, s22
    v_mul_u32_u24 v4, 12, v3
    v_sub_u32 v4, v2, v4
    v_mul_u32_u24 v3, 3072, v3
    v_lshl_add_u32 v3, v4, 7, v3
    v_add_u32 v7, s23, v3
    s_mov_b32 s24, 196608
    s_branch cP_go
cP_x:
    s_mov_b32 s8, s4
    s_mov_b32 s9, s5
    s_mov_b32 s10, 2621440
    s_mov_b32 s11, 0x00020000
    s_sub_u32 s20, s67, 12
    s_lshl_b32 s20, s20, 7
    s_lshr_b32 s23, s65, 1
    s_lshl_b32 s23, s23, 9
    s_add_u32 s20, s20, s23
    v_add_u32 v2, s20, v1
    v_mul_u32_u24 v6, 1280, v2
    v_add_u32 v7, 81920, v6
    s_mov_b32 s24, 128
cP_go:
    s_mul_i32 s25, s24, 9
    s_mov_b32 s26, 1
    s_waitcnt vmcnt(0)
cP_l1:
    buffer_load_dword v10, v6, s[8:11], s25 offen
    buffer_load_dword v11, v7, s[8:11], s25 offen
    s_waitcnt vmcnt(8)
    s_add_u32 s25, s25, s24
    s_sub_u32 s26, s26, 1
    s_cmp_lg_u32 s26, 0
    s_cbranch_scc1 cP_l1
    s_branch c_end
c_act:
    s_mul_i32 s64, s61, 23168
    s_add_u32 s64, s64, 128
    s_load_dwordx2 s[18:19], s[0:1], 120
    s_waitcnt lgkmcnt(0)
    s_mov_b32 s52, s18
    s_mov_b32 s53, s19
    s_mov_b32 s54, 2703360
    s_mov_b32 s55, 0x00020000
    s_add_u32 s56, s18, 3145728
    s_addc_u32 s57, s19, 0
    s_mov_b32 s58, 2703360
    s_mov_b32 s59, 0x00020000
    s_add_u32 s72, s18, 14680064
    s_addc_u32 s73, s19, 0
    s_mov_b32 s74, 212992
    s_mov_b32 s75, 0x00020000
    v_mov_b32 v124, 0
    v_mov_b32 v125, 0
    v_mov_b32 v126, 0
    v_mov_b32 v127, 0
    v_lshlrev_b32 v128, 4, v1
    v_add_u32 v128, s64, v128
    ds_write_b128 v128, v[124:127] offset:17152
    ds_write_b128 v128, v[124:127] offset:18176
    s_waitcnt vmcnt(18)
    v_lshlrev_b32 v26, 16, v26
    v_mul_f32 v26, 0x3fb8aa3b, v26
    v_exp_f32 v26, v26
    s_nop 0
    v_cvt_pk_bf16_f32 v26, v26, v26
    v_lshlrev_b32 v26, 16, v26
    v_and_b32 v44, 7, v1
    v_lshlrev_b32 v120, 7, v1
    v_lshl_add_u32 v120, v44, 4, v120
    v_add_u32 v120, s64, v120
    v_lshrrev_b32 v44, 5, v1
    v_lshlrev_b32 v44, 2, v44
    v_bfe_u32 v45, v1, 3, 1
    v_add_u32 v44, v44, v45
    v_bfe_u32 v45, v1, 2, 1
    v_lshlrev_b32 v45, 2, v45
    v_bfe_u32 v46, v1, 4, 1
    v_lshl_add_u32 v45, v46, 1, v45
    v_bfe_u32 v46, v1, 1, 1
    v_add_u32 v45, v45, v46
    v_xor_b32 v45, v45, v44
    v_lshlrev_b32 v45, 4, v45
    v_lshl_add_u32 v45, v44, 7, v45
    v_and_b32 v46, 1, v1
    v_lshl_add_u32 v45, v46, 3, v45
    v_add_u32 v122, s64, v45
    v_lshrrev_b32 v44, 5, v1
    v_lshlrev_b32 v44, 2, v44
    v_bfe_u32 v45, v1, 3, 1
    v_add_u32 v44, v44, v45
    v_add_u32 v44, 2, v44
    v_bfe_u32 v45, v1, 2, 1
    v_lshlrev_b32 v45, 2, v45
    v_bfe_u32 v46, v1, 4, 1
    v_lshl_add_u32 v45, v46, 1, v45
    v_bfe_u32 v46, v1, 1, 1
    v_add_u32 v45, v45, v46
    v_xor_b32 v45, v45, v44
    v_lshlrev_b32 v45, 4, v45
    v_lshl_add_u32 v45, v44, 7, v45
    v_and_b32 v46, 1, v1
    v_lshl_add_u32 v45, v46, 3, v45
    v_add_u32 v123, s64, v45
    v_xor_b32 v240, 0, v120
    v_xor_b32 v241, 16, v120
    v_xor_b32 v242, 32, v120
    v_xor_b32 v243, 48, v120
    v_xor_b32 v244, 64, v120
    v_xor_b32 v245, 80, v120
    v_xor_b32 v246, 96, v120
    v_xor_b32 v247, 112, v120
    v_mov_b32 v104, 0
    v_mov_b32 v105, 0
    v_mov_b32 v106, 0
    v_mov_b32 v107, 0
    v_mov_b32 v108, 0
    v_mov_b32 v109, 0
    v_mov_b32 v110, 0
    v_mov_b32 v111, 0
    v_mov_b32 v112, 0
    v_mov_b32 v113, 0
    v_mov_b32 v114, 0
    v_mov_b32 v115, 0
    v_mov_b32 v116, 0
    v_mov_b32 v117, 0
    v_mov_b32 v118, 0
    v_mov_b32 v119, 0
    s_waitcnt vmcnt(0)
    s_mov_b32 s63, 3
c_kl:
    v_lshlrev_b32 v8, 16, v8
    v_lshlrev_b32 v9, 16, v9
    v_lshlrev_b32 v10, 16, v10
    v_lshlrev_b32 v11, 16, v11
    v_lshlrev_b32 v12, 16, v12
    v_lshlrev_b32 v13, 16, v13
    v_mul_f32 v28, v26, v8
    v_mul_f32 v29, v26, v9
    v_mul_f32 v10, v26, v10
    v_mul_f32 v11, v26, v11
    v_mul_f32 v28, 0x3fb8aa3b, v28
    v_mul_f32 v29, 0x3e22f983, v29
    v_mul_f32 v30, v12, v10
    v_mul_f32 v31, v12, v11
    v_fma_f32 v30, -v13, v11, v30
    v_fmac_f32 v31, v13, v10
    v_exp_f32 v44, v28
    v_fract_f32 v45, v29
    v_cos_f32 v32, v45
    v_sin_f32 v33, v45
    v_mul_f32 v32, v32, v44
    v_mul_f32 v33, v33, v44
    v_mul_f32 v44, 0x41000000, v28
    v_mul_f32 v45, 0x41000000, v29
    v_exp_f32 v44, v44
    v_fract_f32 v45, v45
    v_cos_f32 v38, v45
    v_sin_f32 v39, v45
    v_mul_f32 v38, v38, v44
    v_mul_f32 v39, v39, v44
    v_mul_f32 v44, 0x43800000, v28
    v_mul_f32 v45, 0x43800000, v29
    v_exp_f32 v44, v44
    v_fract_f32 v45, v45
    v_cos_f32 v42, v45
    v_sin_f32 v43, v45
    v_mul_f32 v42, v42, v44
    v_mul_f32 v43, v43, v44
    v_mul_f32 v34, v32, v32
    v_mul_f32 v35, v32, v33
    v_mul_f32 v40, v38, v38
    v_mul_f32 v41, v38, v39
    v_fma_f32 v34, -v33, v33, v34
    v_fmac_f32 v35, v33, v32
    v_fma_f32 v40, -v39, v39, v40
    v_fmac_f32 v41, v39, v38
    v_mul_f32 v36, v34, v34
    v_mul_f32 v37, v34, v35
    v_fma_f32 v36, -v35, v35, v36
    v_fmac_f32 v37, v35, v34
    v_mul_f32 v48, v30, v32
    v_mul_f32 v49, v30, v33
    v_mul_f32 v50, v30, v42
    v_mul_f32 v51, v30, v43
    v_fma_f32 v48, -v31, v33, v48
    v_fmac_f32 v49, v31, v32
    v_fma_f32 v50, -v31, v43, v50
    v_fmac_f32 v51, v31, v42
    v_mul_f32 v52, v30, v34
    v_mul_f32 v53, v30, v35
    v_mul_f32 v54, v48, v34
    v_mul_f32 v55, v48, v35
    v_mul_f32 v56, v50, v34
    v_mul_f32 v57, v50, v35
    v_fma_f32 v52, -v31, v35, v52
    v_fmac_f32 v53, v31, v34
    v_fma_f32 v54, -v49, v35, v54
    v_fmac_f32 v55, v49, v34
    v_fma_f32 v56, -v51, v35, v56
    v_fmac_f32 v57, v51, v34
    v_mul_f32 v58, v56, v34
    v_mul_f32 v59, v56, v35
    v_mul_f32 v60, v52, v34
    v_mul_f32 v61, v52, v35
    v_mul_f32 v62, v54, v34
    v_mul_f32 v63, v54, v35
    v_fma_f32 v58, -v57, v35, v58
    v_fmac_f32 v59, v57, v34
    v_fma_f32 v60, -v53, v35, v60
    v_fmac_f32 v61, v53, v34
    v_fma_f32 v62, -v55, v35, v62
    v_fmac_f32 v63, v55, v34
    v_cvt_pk_bf16_f32 v80, v30, v48
    v_cvt_pk_bf16_f32 v81, v52, v54
    v_cvt_pk_bf16_f32 v82, v50, v50
    v_cvt_pk_bf16_f32 v83, v56, v58
    v_cvt_pk_bf16_f32 v84, -v31, -v49
    v_cvt_pk_bf16_f32 v85, -v53, -v55
    v_cvt_pk_bf16_f32 v86, -v51, -v51
    v_cvt_pk_bf16_f32 v87, -v57, -v59
    ds_write_b128 v240, v[80:83] offset:0
    ds_write_b128 v244, v[84:87] offset:0
    v_mul_f32 v56, v60, v34
    v_mul_f32 v57, v60, v35
    v_mul_f32 v54, v62, v34
    v_mul_f32 v55, v62, v35
    v_mul_f32 v52, v58, v34
    v_mul_f32 v53, v58, v35
    v_mul_f32 v48, v50, v42
    v_mul_f32 v49, v50, v43
    v_fma_f32 v56, -v61, v35, v56
    v_fmac_f32 v57, v61, v34
    v_fma_f32 v54, -v63, v35, v54
    v_fmac_f32 v55, v63, v34
    v_fma_f32 v52, -v59, v35, v52
    v_fmac_f32 v53, v59, v34
    v_fma_f32 v48, -v51, v43, v48
    v_fmac_f32 v49, v51, v42
    v_mul_f32 v50, v52, v34
    v_mul_f32 v51, v52, v35
    v_mul_f32 v64, v48, v36
    v_mul_f32 v65, v48, v37
    v_mul_f32 v66, v48, v42
    v_mul_f32 v67, v48, v43
    v_fma_f32 v50, -v53, v35, v50
    v_fmac_f32 v51, v53, v34
    v_fma_f32 v64, -v49, v37, v64
    v_fmac_f32 v65, v49, v36
    v_fma_f32 v66, -v49, v43, v66
    v_fmac_f32 v67, v49, v42
    v_cvt_pk_bf16_f32 v80, v60, v62
    v_cvt_pk_bf16_f32 v81, v56, v54
    v_cvt_pk_bf16_f32 v82, v58, v58
    v_cvt_pk_bf16_f32 v83, v52, v50
    v_cvt_pk_bf16_f32 v84, -v61, -v63
    v_cvt_pk_bf16_f32 v85, -v57, -v55
    v_cvt_pk_bf16_f32 v86, -v59, -v59
    v_cvt_pk_bf16_f32 v87, -v53, -v51
    ds_write_b128 v241, v[80:83] offset:0
    ds_write_b128 v245, v[84:87] offset:0
    v_mul_f32 v50, v64, v36
    v_mul_f32 v51, v64, v37
    v_mul_f32 v52, v66, v36
    v_mul_f32 v53, v66, v37
    v_mul_f32 v58, v66, v42
    v_mul_f32 v59, v66, v43
    v_fma_f32 v50, -v65, v37, v50
    v_fmac_f32 v51, v65, v36
    v_fma_f32 v52, -v67, v37, v52
    v_fmac_f32 v53, v67, v36
    v_fma_f32 v58, -v67, v43, v58
    v_fmac_f32 v59, v67, v42
    v_mul_f32 v54, v52, v36
    v_mul_f32 v55, v52, v37
    v_mul_f32 v56, v58, v42
    v_mul_f32 v57, v58, v43
    v_mul_f32 v62, v58, v38
    v_mul_f32 v63, v58, v39
    v_fma_f32 v54, -v53, v37, v54
    v_fmac_f32 v55, v53, v36
    v_fma_f32 v56, -v59, v43, v56
    v_fmac_f32 v57, v59, v42
    v_fma_f32 v62, -v59, v39, v62
    v_fmac_f32 v63, v59, v38
    v_mul_f32 v60, v56, v42
    v_mul_f32 v61, v56, v43
    v_mul_f32 v68, v56, v38
    v_mul_f32 v69, v56, v39
    v_fma_f32 v60, -v57, v43, v60
    v_fmac_f32 v61, v57, v42
    v_fma_f32 v68, -v57, v39, v68
    v_fmac_f32 v69, v57, v38
    v_cvt_pk_bf16_f32 v80, v48, v64
    v_cvt_pk_bf16_f32 v81, v50, v58
    v_cvt_pk_bf16_f32 v82, v66, v52
    v_cvt_pk_bf16_f32 v83, v54, v60
    v_cvt_pk_bf16_f32 v84, -v49, -v65
    v_cvt_pk_bf16_f32 v85, -v51, -v59
    v_cvt_pk_bf16_f32 v86, -v67, -v53
    v_cvt_pk_bf16_f32 v87, -v55, -v61
    ds_write_b128 v242, v[80:83] offset:0
    ds_write_b128 v246, v[84:87] offset:0
    v_mul_f32 v54, v60, v38
    v_mul_f32 v55, v60, v39
    v_mul_f32 v52, v60, v42
    v_mul_f32 v53, v60, v43
    v_fma_f32 v54, -v61, v39, v54
    v_fmac_f32 v55, v61, v38
    v_fma_f32 v52, -v61, v43, v52
    v_fmac_f32 v53, v61, v42
    v_mul_f32 v66, v52, v38
    v_mul_f32 v67, v52, v39
    v_fma_f32 v66, -v53, v39, v66
    v_fmac_f32 v67, v53, v38
    v_cvt_pk_bf16_f32 v80, v62, v56
    v_cvt_pk_bf16_f32 v81, v68, v62
    v_cvt_pk_bf16_f32 v82, v54, v52
    v_cvt_pk_bf16_f32 v83, v66, v62
    v_cvt_pk_bf16_f32 v84, -v63, -v57
    v_cvt_pk_bf16_f32 v85, -v69, -v63
    v_cvt_pk_bf16_f32 v86, -v55, -v53
    v_cvt_pk_bf16_f32 v87, -v67, -v63
    ds_write_b128 v243, v[80:83] offset:0
    ds_write_b128 v247, v[84:87] offset:0
    v_mov_b32 v48, 1.0
    v_mov_b32 v49, 0
    v_mov_b32 v50, v38
    v_mov_b32 v51, v39
    v_mul_f32 v52, v48, v40
    v_mul_f32 v53, v48, v41
    v_mul_f32 v54, v50, v40
    v_mul_f32 v55, v50, v41
    v_fma_f32 v52, -v49, v41, v52
    v_fmac_f32 v53, v49, v40
    v_fma_f32 v54, -v51, v41, v54
    v_fmac_f32 v55, v51, v40
    v_mul_f32 v56, v52, v40
    v_mul_f32 v57, v52, v41
    v_mul_f32 v58, v54, v40
    v_mul_f32 v59, v54, v41
    v_fma_f32 v56, -v53, v41, v56
    v_fmac_f32 v57, v53, v40
    v_fma_f32 v58, -v55, v41, v58
    v_fmac_f32 v59, v55, v40
    v_mul_f32 v60, v56, v40
    v_mul_f32 v61, v56, v41
    v_mul_f32 v62, v58, v40
    v_mul_f32 v63, v58, v41
    v_fma_f32 v60, -v57, v41, v60
    v_fmac_f32 v61, v57, v40
    v_fma_f32 v62, -v59, v41, v62
    v_fmac_f32 v63, v59, v40
    v_cvt_pk_bf16_f32 v80, v48, v50
    v_cvt_pk_bf16_f32 v81, v52, v54
    v_cvt_pk_bf16_f32 v82, v56, v58
    v_cvt_pk_bf16_f32 v83, v60, v62
    v_cvt_pk_bf16_f32 v84, v49, v51
    v_cvt_pk_bf16_f32 v85, v53, v55
    v_cvt_pk_bf16_f32 v86, v57, v59
    v_cvt_pk_bf16_f32 v87, v61, v63
    ds_write_b128 v240, v[80:83] offset:8192
    ds_write_b128 v244, v[84:87] offset:8192
    v_mul_f32 v64, v60, v40
    v_mul_f32 v65, v60, v41
    v_mul_f32 v66, v62, v40
    v_mul_f32 v67, v62, v41
    v_fma_f32 v64, -v61, v41, v64
    v_fmac_f32 v65, v61, v40
    v_fma_f32 v66, -v63, v41, v66
    v_fmac_f32 v67, v63, v40
    v_mul_f32 v68, v64, v40
    v_mul_f32 v69, v64, v41
    v_mul_f32 v70, v66, v40
    v_mul_f32 v71, v66, v41
    v_fma_f32 v68, -v65, v41, v68
    v_fmac_f32 v69, v65, v40
    v_fma_f32 v70, -v67, v41, v70
    v_fmac_f32 v71, v67, v40
    v_mul_f32 v72, v68, v40
    v_mul_f32 v73, v68, v41
    v_mul_f32 v74, v70, v40
    v_mul_f32 v75, v70, v41
    v_fma_f32 v72, -v69, v41, v72
    v_fmac_f32 v73, v69, v40
    v_fma_f32 v74, -v71, v41, v74
    v_fmac_f32 v75, v71, v40
    v_mul_f32 v76, v72, v40
    v_mul_f32 v77, v72, v41
    v_mul_f32 v78, v74, v40
    v_mul_f32 v79, v74, v41
    v_fma_f32 v76, -v73, v41, v76
    v_fmac_f32 v77, v73, v40
    v_fma_f32 v78, -v75, v41, v78
    v_fmac_f32 v79, v75, v40
    v_cvt_pk_bf16_f32 v80, v64, v66
    v_cvt_pk_bf16_f32 v81, v68, v70
    v_cvt_pk_bf16_f32 v82, v72, v74
    v_cvt_pk_bf16_f32 v83, v76, v78
    v_cvt_pk_bf16_f32 v84, v65, v67
    v_cvt_pk_bf16_f32 v85, v69, v71
    v_cvt_pk_bf16_f32 v86, v73, v75
    v_cvt_pk_bf16_f32 v87, v77, v79
    ds_write_b128 v241, v[80:83] offset:8192
    ds_write_b128 v245, v[84:87] offset:8192
    v_mul_f32 v48, v76, v40
    v_mul_f32 v49, v76, v41
    v_mul_f32 v50, v78, v40
    v_mul_f32 v51, v78, v41
    v_fma_f32 v48, -v77, v41, v48
    v_fmac_f32 v49, v77, v40
    v_fma_f32 v50, -v79, v41, v50
    v_fmac_f32 v51, v79, v40
    v_mul_f32 v52, v48, v40
    v_mul_f32 v53, v48, v41
    v_mul_f32 v54, v50, v40
    v_mul_f32 v55, v50, v41
    v_fma_f32 v52, -v49, v41, v52
    v_fmac_f32 v53, v49, v40
    v_fma_f32 v54, -v51, v41, v54
    v_fmac_f32 v55, v51, v40
    v_mul_f32 v56, v52, v40
    v_mul_f32 v57, v52, v41
    v_mul_f32 v58, v54, v40
    v_mul_f32 v59, v54, v41
    v_fma_f32 v56, -v53, v41, v56
    v_fmac_f32 v57, v53, v40
    v_fma_f32 v58, -v55, v41, v58
    v_fmac_f32 v59, v55, v40
    v_mul_f32 v60, v56, v40
    v_mul_f32 v61, v56, v41
    v_mul_f32 v62, v58, v40
    v_mul_f32 v63, v58, v41
    v_fma_f32 v60, -v57, v41, v60
    v_fmac_f32 v61, v57, v40
    v_fma_f32 v62, -v59, v41, v62
    v_fmac_f32 v63, v59, v40
    v_cvt_pk_bf16_f32 v80, v48, v50
    v_cvt_pk_bf16_f32 v81, v52, v54
    v_cvt_pk_bf16_f32 v82, v56, v58
    v_cvt_pk_bf16_f32 v83, v60, v62
    v_cvt_pk_bf16_f32 v84, v49, v51
    v_cvt_pk_bf16_f32 v85, v53, v55
    v_cvt_pk_bf16_f32 v86, v57, v59
    v_cvt_pk_bf16_f32 v87, v61, v63
    ds_write_b128 v242, v[80:83] offset:8192
    ds_write_b128 v246, v[84:87] offset:8192
    v_mul_f32 v64, v60, v40
    v_mul_f32 v65, v60, v41
    v_mul_f32 v66, v62, v40
    v_mul_f32 v67, v62, v41
    v_fma_f32 v64, -v61, v41, v64
    v_fmac_f32 v65, v61, v40
    v_fma_f32 v66, -v63, v41, v66
    v_fmac_f32 v67, v63, v40
    v_mul_f32 v68, v64, v40
    v_mul_f32 v69, v64, v41
    v_mul_f32 v70, v66, v40
    v_mul_f32 v71, v66, v41
    v_fma_f32 v68, -v65, v41, v68
    v_fmac_f32 v69, v65, v40
    v_fma_f32 v70, -v67, v41, v70
    v_fmac_f32 v71, v67, v40
    v_mul_f32 v72, v68, v40
    v_mul_f32 v73, v68, v41
    v_mul_f32 v74, v70, v40
    v_mul_f32 v75, v70, v41
    v_fma_f32 v72, -v69, v41, v72
    v_fmac_f32 v73, v69, v40
    v_fma_f32 v74, -v71, v41, v74
    v_fmac_f32 v75, v71, v40
    v_mul_f32 v76, v72, v40
    v_mul_f32 v77, v72, v41
    v_mul_f32 v78, v74, v40
    v_mul_f32 v79, v74, v41
    v_fma_f32 v76, -v73, v41, v76
    v_fmac_f32 v77, v73, v40
    v_fma_f32 v78, -v75, v41, v78
    v_fmac_f32 v79, v75, v40
    v_cvt_pk_bf16_f32 v80, v64, v66
    v_cvt_pk_bf16_f32 v81, v68, v70
    v_cvt_pk_bf16_f32 v82, v72, v74
    v_cvt_pk_bf16_f32 v83, v76, v78
    v_cvt_pk_bf16_f32 v84, v65, v67
    v_cvt_pk_bf16_f32 v85, v69, v71
    v_cvt_pk_bf16_f32 v86, v73, v75
    v_cvt_pk_bf16_f32 v87, v77, v79
    ds_write_b128 v243, v[80:83] offset:8192
    ds_write_b128 v247, v[84:87] offset:8192
    s_waitcnt lgkmcnt(0)
    ds_read_b64_tr_b16 v[168:169], v122 offset:0
    ds_read_b64_tr_b16 v[170:171], v123 offset:0
    ds_read_b64_tr_b16 v[172:173], v122 offset:8192
    ds_read_b64_tr_b16 v[174:175], v123 offset:8192
    ds_read_b64_tr_b16 v[176:177], v122 offset:1024
    ds_read_b64_tr_b16 v[178:179], v123 offset:1024
    ds_read_b64_tr_b16 v[180:181], v122 offset:9216
    ds_read_b64_tr_b16 v[182:183], v123 offset:9216
    ds_read_b64_tr_b16 v[184:185], v122 offset:2048
    ds_read_b64_tr_b16 v[186:187], v123 offset:2048
    ds_read_b64_tr_b16 v[188:189], v122 offset:10240
    ds_read_b64_tr_b16 v[190:191], v123 offset:10240
    s_waitcnt lgkmcnt(8)
    ds_read_b64_tr_b16 v[192:193], v122 offset:3072
    ds_read_b64_tr_b16 v[194:195], v123 offset:3072
    ds_read_b64_tr_b16 v[196:197], v122 offset:11264
    ds_read_b64_tr_b16 v[198:199], v123 offset:11264
    v_mfma_f32_32x32x16_bf16 v[104:119], v[168:171], v[172:175], v[104:119]
    s_waitcnt lgkmcnt(8)
    ds_read_b64_tr_b16 v[200:201], v122 offset:4096
    ds_read_b64_tr_b16 v[202:203], v123 offset:4096
    ds_read_b64_tr_b16 v[204:205], v122 offset:12288
    ds_read_b64_tr_b16 v[206:207], v123 offset:12288
    v_mfma_f32_32x32x16_bf16 v[104:119], v[176:179], v[180:183], v[104:119]
    s_waitcnt lgkmcnt(8)
    ds_read_b64_tr_b16 v[208:209], v122 offset:5120
    ds_read_b64_tr_b16 v[210:211], v123 offset:5120
    ds_read_b64_tr_b16 v[212:213], v122 offset:13312
    ds_read_b64_tr_b16 v[214:215], v123 offset:13312
    v_mfma_f32_32x32x16_bf16 v[104:119], v[184:187], v[188:191], v[104:119]
    s_waitcnt lgkmcnt(8)
    ds_read_b64_tr_b16 v[216:217], v122 offset:6144
    ds_read_b64_tr_b16 v[218:219], v123 offset:6144
    ds_read_b64_tr_b16 v[220:221], v122 offset:14336
    ds_read_b64_tr_b16 v[222:223], v123 offset:14336
    v_mfma_f32_32x32x16_bf16 v[104:119], v[192:195], v[196:199], v[104:119]
    s_waitcnt lgkmcnt(8)
    ds_read_b64_tr_b16 v[224:225], v122 offset:7168
    ds_read_b64_tr_b16 v[226:227], v123 offset:7168
    ds_read_b64_tr_b16 v[228:229], v122 offset:15360
    ds_read_b64_tr_b16 v[230:231], v123 offset:15360
    v_mfma_f32_32x32x16_bf16 v[104:119], v[200:203], v[204:207], v[104:119]
    s_waitcnt lgkmcnt(8)
    v_mfma_f32_32x32x16_bf16 v[104:119], v[208:211], v[212:215], v[104:119]
    s_waitcnt lgkmcnt(4)
    v_mfma_f32_32x32x16_bf16 v[104:119], v[216:219], v[220:223], v[104:119]
    s_waitcnt lgkmcnt(0)
    v_mfma_f32_32x32x16_bf16 v[104:119], v[224:227], v[228:231], v[104:119]
    v_mov_b32 v8, v14
    v_mov_b32 v9, v15
    v_mov_b32 v10, v16
    v_mov_b32 v11, v17
    v_mov_b32 v12, v18
    v_mov_b32 v13, v19
    v_mov_b32 v14, v20
    v_mov_b32 v15, v21
    v_mov_b32 v16, v22
    v_mov_b32 v17, v23
    v_mov_b32 v18, v24
    v_mov_b32 v19, v25
    s_sub_u32 s63, s63, 1
    s_cmp_lg_u32 s63, 0
    s_cbranch_scc1 c_kl
    v_and_b32 v44, 31, v1
    v_lshrrev_b32 v45, 5, v1
    v_lshlrev_b32 v44, 4, v44
    v_sub_u32 v44, 3056, v44
    v_add_u32 v44, s64, v44
    v_lshlrev_b32 v46, 9, v45
    v_sub_u32 v124, v44, v46
    v_sub_u32 v125, v124, v46
    v_subrev_u32 v125, 1536, v125
    v_and_b32 v44, 1, v1
    v_cmp_eq_u32 vcc, 1, v44
    s_nop 1
    v_cndmask_b32 v46, v115, v116, vcc
    v_cndmask_b32 v47, v117, v118, vcc
    v_cvt_pk_bf16_f32 v48, v111, v110
    v_cvt_pk_bf16_f32 v49, v109, v108
    v_cvt_pk_bf16_f32 v50, v107, v106
    v_cvt_pk_bf16_f32 v51, v105, v104
    ds_write_b128 v124, v[48:51] offset:1024
    v_cvt_pk_bf16_f32 v52, v114, v114
    v_cvt_pk_bf16_f32 v53, v113, v113
    v_cvt_pk_bf16_f32 v54, v113, v112
    v_cvt_pk_bf16_f32 v55, v112, v112
    ds_write_b128 v124, v[52:55]
    v_cvt_pk_bf16_f32 v56, v116, v116
    v_cvt_pk_bf16_f32 v57, v116, v46
    v_cvt_pk_bf16_f32 v58, v115, v115
    v_cvt_pk_bf16_f32 v59, v115, v115
    ds_write_b128 v125, v[56:59] offset:512
    v_cvt_pk_bf16_f32 v60, v118, v118
    v_cvt_pk_bf16_f32 v61, v118, v47
    v_cvt_pk_bf16_f32 v62, v117, v117
    v_cvt_pk_bf16_f32 v63, v117, v117
    ds_write_b128 v125, v[60:63]
    v_bfe_u32 v44, v1, 3, 2
    v_mul_u32_u24 v44, 4288, v44
    v_and_b32 v45, 7, v1
    v_lshl_add_u32 v44, v45, 4, v44
    v_add_u32 v44, s64, v44
    v_mov_b32 v64, 0
    v_mov_b32 v65, 0
    v_mov_b32 v66, 0
    v_mov_b32 v67, 0
    ds_write_b128 v44, v[64:67] offset:4096
    v_lshlrev_b32 v44, 4, v1
    v_add_u32 v44, s64, v44
    s_waitcnt lgkmcnt(0)
    ds_read_b128 v[48:51], v44 offset:0
    ds_read_b64 v[52:53], v44 offset:16
    s_waitcnt lgkmcnt(0)
    v_alignbit_b32 v64, v49, v48, 16
    v_alignbit_b32 v65, v50, v49, 16
    v_alignbit_b32 v66, v51, v50, 16
    v_alignbit_b32 v67, v52, v51, 16
    v_mov_b32 v68, v49
    v_mov_b32 v69, v50
    v_mov_b32 v70, v51
    v_mov_b32 v71, v52
    v_alignbit_b32 v72, v50, v49, 16
    v_alignbit_b32 v73, v51, v50, 16
    v_alignbit_b32 v74, v52, v51, 16
    v_alignbit_b32 v75, v53, v52, 16
    ds_write_b128 v44, v[64:67] offset:4288
    ds_write_b128 v44, v[68:71] offset:8576
    ds_write_b128 v44, v[72:75] offset:12864
    ds_read_b128 v[56:59], v44 offset:1024
    ds_read_b64 v[60:61], v44 offset:1040
    s_waitcnt lgkmcnt(0)
    v_alignbit_b32 v64, v57, v56, 16
    v_alignbit_b32 v65, v58, v57, 16
    v_alignbit_b32 v66, v59, v58, 16
    v_alignbit_b32 v67, v60, v59, 16
    v_mov_b32 v68, v57
    v_mov_b32 v69, v58
    v_mov_b32 v70, v59
    v_mov_b32 v71, v60
    v_alignbit_b32 v72, v58, v57, 16
    v_alignbit_b32 v73, v59, v58, 16
    v_alignbit_b32 v74, v60, v59, 16
    v_alignbit_b32 v75, v61, v60, 16
    ds_write_b128 v44, v[64:67] offset:5312
    ds_write_b128 v44, v[68:71] offset:9600
    ds_write_b128 v44, v[72:75] offset:13888
    ds_read_b128 v[48:51], v44 offset:2048
    ds_read_b64 v[52:53], v44 offset:2064
    s_waitcnt lgkmcnt(0)
    v_alignbit_b32 v64, v49, v48, 16
    v_alignbit_b32 v65, v50, v49, 16
    v_alignbit_b32 v66, v51, v50, 16
    v_alignbit_b32 v67, v52, v51, 16
    v_mov_b32 v68, v49
    v_mov_b32 v69, v50
    v_mov_b32 v70, v51
    v_mov_b32 v71, v52
    v_alignbit_b32 v72, v50, v49, 16
    v_alignbit_b32 v73, v51, v50, 16
    v_alignbit_b32 v74, v52, v51, 16
    v_alignbit_b32 v75, v53, v52, 16
    ds_write_b128 v44, v[64:67] offset:6336
    ds_write_b128 v44, v[68:71] offset:10624
    ds_write_b128 v44, v[72:75] offset:14912
    ds_read_b128 v[56:59], v44 offset:3072
    ds_read_b64 v[60:61], v44 offset:3088
    s_waitcnt lgkmcnt(0)
    v_alignbit_b32 v64, v57, v56, 16
    v_alignbit_b32 v65, v58, v57, 16
    v_alignbit_b32 v66, v59, v58, 16
    v_alignbit_b32 v67, v60, v59, 16
    v_mov_b32 v68, v57
    v_mov_b32 v69, v58
    v_mov_b32 v70, v59
    v_mov_b32 v71, v60
    v_alignbit_b32 v72, v58, v57, 16
    v_alignbit_b32 v73, v59, v58, 16
    v_alignbit_b32 v74, v60, v59, 16
    v_alignbit_b32 v75, v61, v60, 16
    ds_write_b128 v44, v[64:67] offset:7360
    ds_write_b128 v44, v[68:71] offset:11648
    ds_write_b128 v44, v[72:75] offset:15936
    s_load_dwordx2 s[20:21], s[0:1], 112
    v_mov_b32 v125, 0
    s_mov_b32 s22, 4096
    s_waitcnt lgkmcnt(0)
c_n1_nl:
    global_load_dword v124, v125, s[20:21] sc1
    s_waitcnt vmcnt(0)
    v_readfirstlane_b32 s70, v124
    s_sub_u32 s22, s22, 1
    s_cmp_eq_u32 s22, 0
    s_cbranch_scc1 c_n1_nd
    s_cmp_eq_u32 s70, 0
    s_cbranch_scc0 c_n1_nd
    s_sleep 4
    s_branch c_n1_nl
c_n1_nd:
    v_and_b32 v132, 31, v1
    s_lshl_b32 s22, s65, 5
    v_add_u32 v132, s22, v132
    v_lshlrev_b32 v132, 7, v132
    s_mov_b32 s20, 4096
    s_mov_b32 s21, 0
c_pl_pl:
    buffer_load_dword v124, v132, s[72:75], s21 offen sc1
    s_waitcnt vmcnt(0)
    v_xor_b32 v124, s70, v124
    v_cmp_ne_u32 vcc, 0, v124
    s_sub_u32 s20, s20, 1
    s_cmp_eq_u32 s20, 0
    s_cbranch_scc1 c_pl_pd
    s_nop 1
    s_cbranch_vccz c_pl_pd
    s_sleep 4
    s_branch c_pl_pl
c_pl_pd:
    v_lshrrev_b32 v128, 3, v1
    v_add_u32 v129, 7, v128
    v_and_b32 v129, 7, v129
    v_and_b32 v130, 7, v1
    v_xor_b32 v129, v129, v130
    v_lshlrev_b32 v128, 7, v128
    v_lshl_add_u32 v128, v129, 4, v128
    s_mul_i32 s20, s60, 4224
    s_add_u32 s21, s64, 19072
    s_mov_b32 m0, s21
    s_nop 0
    buffer_load_dwordx4 v128, s[52:55], s20 offen offset:0 sc1 lds
    buffer_load_dwordx4 v128, s[52:55], s20 offen offset:1024 sc1 lds
    buffer_load_dwordx4 v128, s[52:55], s20 offen offset:2048 sc1 lds
    buffer_load_dwordx4 v128, s[52:55], s20 offen offset:3072 sc1 lds
    v_and_b32 v44, 15, v1
    v_sub_u32 v45, 3, v44
    v_and_b32 v45, 3, v45
    v_mul_u32_u24 v45, 4288, v45
    v_and_b32 v46, 12, v44
    v_lshlrev_b32 v46, 1, v46
    v_sub_u32 v45, v45, v46
    v_lshrrev_b32 v47, 4, v1
    v_lshl_add_u32 v45, v47, 4, v45
    v_add_u32 v45, 24, v45
    v_add_u32 v248, s64, v45
    s_add_u32 s22, s64, 17152
    v_add_u32 v240, 15, v44
    v_mov_b32 v241, v47
    v_mov_b32 v136, 0
    v_mov_b32 v137, 0
    v_mov_b32 v138, 0
    v_mov_b32 v139, 0
    v_mov_b32 v140, 0
    v_mov_b32 v141, 0
    v_mov_b32 v142, 0
    v_mov_b32 v143, 0
    v_mov_b32 v144, 0
    v_mov_b32 v145, 0
    v_mov_b32 v146, 0
    v_mov_b32 v147, 0
    v_mov_b32 v148, 0
    v_mov_b32 v149, 0
    v_mov_b32 v150, 0
    v_mov_b32 v151, 0
    v_mov_b32 v152, 0
    v_mov_b32 v153, 0
    v_mov_b32 v154, 0
    v_mov_b32 v155, 0
    v_mov_b32 v156, 0
    v_mov_b32 v157, 0
    v_mov_b32 v158, 0
    v_mov_b32 v159, 0
    v_mov_b32 v160, 0
    v_mov_b32 v161, 0
    v_mov_b32 v162, 0
    v_mov_b32 v163, 0
    v_mov_b32 v164, 0
    v_mov_b32 v165, 0
    v_mov_b32 v166, 0
    v_mov_b32 v167, 0
    s_waitcnt vmcnt(0) lgkmcnt(0)
    v_add_u32 v248, 3968, v248
    v_mov_b32 v242, v240
    v_and_b32 v243, 7, v242
    v_xor_b32 v243, v243, v241
    v_lshlrev_b32 v242, 7, v242
    v_lshl_add_u32 v242, v243, 4, v242
    v_add_u32 v232, s22, v242
    v_xor_b32 v233, 64, v232
    ds_read_b64 v[176:177], v248 offset:160
    ds_read_b64 v[178:179], v248 offset:168
    ds_read_b64 v[172:173], v248 offset:128
    ds_read_b64 v[174:175], v248 offset:136
    ds_read_b64 v[168:169], v248 offset:96
    ds_read_b64 v[170:171], v248 offset:104
    ds_read_b64 v[196:197], v248 offset:64
    ds_read_b64 v[198:199], v248 offset:72
    ds_read_b128 v[200:203], v233 offset:0
    ds_read_b128 v[204:207], v233 offset:2048
    s_waitcnt lgkmcnt(8)
    ds_read_b64 v[192:193], v248 offset:32
    ds_read_b64 v[194:195], v248 offset:40
    ds_read_b64 v[188:189], v248 offset:0
    ds_read_b64 v[190:191], v248 offset:8
    ds_read_b128 v[208:211], v232 offset:0
    ds_read_b128 v[212:215], v232 offset:2048
    v_subrev_u32 v240, 1, v240
    v_subrev_u32 v248, 512, v248
    v_mov_b32 v242, v240
    v_and_b32 v243, 7, v242
    v_xor_b32 v243, v243, v241
    v_lshlrev_b32 v242, 7, v242
    v_lshl_add_u32 v242, v243, 4, v242
    v_add_u32 v232, s22, v242
    v_xor_b32 v233, 64, v232
    v_subrev_u32 v242, 1, v240
    v_and_b32 v243, 7, v242
    v_xor_b32 v243, v243, v241
    v_lshlrev_b32 v242, 7, v242
    v_lshl_add_u32 v242, v243, 4, v242
    v_add_u32 v234, s22, v242
    v_xor_b32 v235, 64, v234
    v_subrev_u32 v242, 2, v240
    v_and_b32 v243, 7, v242
    v_xor_b32 v243, v243, v241
    v_lshlrev_b32 v242, 7, v242
    v_lshl_add_u32 v242, v243, 4, v242
    v_add_u32 v236, s22, v242
    v_xor_b32 v237, 64, v236
    s_mov_b32 s63, 4
c_cv1:
    s_waitcnt lgkmcnt(6)
    ds_read_b64 v[184:185], v248 offset:480
    ds_read_b64 v[186:187], v248 offset:488
    ds_read_b64 v[180:181], v248 offset:448
    ds_read_b64 v[182:183], v248 offset:456
    ds_read_b128 v[216:219], v233 offset:0
    ds_read_b128 v[220:223], v233 offset:2048
    v_mfma_f32_16x16x32_bf16 v[140:143], v[176:179], v[204:207], v[140:143]
    v_subrev_u32 v242, 3, v240
    v_mfma_f32_16x16x32_bf16 v[148:151], v[172:175], v[204:207], v[148:151]
    v_and_b32 v243, 7, v242
    v_mfma_f32_16x16x32_bf16 v[156:159], v[168:171], v[204:207], v[156:159]
    v_xor_b32 v243, v243, v241
    v_mfma_f32_16x16x32_bf16 v[164:167], v[196:199], v[204:207], v[164:167]
    v_lshlrev_b32 v242, 7, v242
    v_mfma_f32_16x16x32_bf16 v[136:139], v[176:179], v[200:203], v[136:139]
    v_mfma_f32_16x16x32_bf16 v[144:147], v[172:175], v[200:203], v[144:147]
    v_mfma_f32_16x16x32_bf16 v[152:155], v[168:171], v[200:203], v[152:155]
    v_mfma_f32_16x16x32_bf16 v[160:163], v[196:199], v[200:203], v[160:163]
    s_waitcnt lgkmcnt(6)
    ds_read_b64 v[176:177], v248 offset:416
    ds_read_b64 v[178:179], v248 offset:424
    ds_read_b64 v[172:173], v248 offset:384
    ds_read_b64 v[174:175], v248 offset:392
    ds_read_b128 v[224:227], v232 offset:0
    ds_read_b128 v[228:231], v232 offset:2048
    v_mfma_f32_16x16x32_bf16 v[140:143], v[168:171], v[212:215], v[140:143]
    v_lshl_add_u32 v242, v243, 4, v242
    v_mfma_f32_16x16x32_bf16 v[148:151], v[196:199], v[212:215], v[148:151]
    v_add_u32 v238, s22, v242
    v_mfma_f32_16x16x32_bf16 v[156:159], v[192:195], v[212:215], v[156:159]
    v_xor_b32 v239, 64, v238
    v_mfma_f32_16x16x32_bf16 v[164:167], v[188:191], v[212:215], v[164:167]
    v_mfma_f32_16x16x32_bf16 v[136:139], v[168:171], v[208:211], v[136:139]
    v_mfma_f32_16x16x32_bf16 v[144:147], v[196:199], v[208:211], v[144:147]
    v_mfma_f32_16x16x32_bf16 v[152:155], v[192:195], v[208:211], v[152:155]
    v_mfma_f32_16x16x32_bf16 v[160:163], v[188:191], v[208:211], v[160:163]
    s_waitcnt lgkmcnt(6)
    ds_read_b64 v[168:169], v248 offset:352
    ds_read_b64 v[170:171], v248 offset:360
    ds_read_b64 v[196:197], v248 offset:320
    ds_read_b64 v[198:199], v248 offset:328
    ds_read_b128 v[200:203], v235 offset:0
    ds_read_b128 v[204:207], v235 offset:2048
    v_mfma_f32_16x16x32_bf16 v[140:143], v[192:195], v[220:223], v[140:143]
    v_subrev_u32 v242, 4, v240
    v_mfma_f32_16x16x32_bf16 v[148:151], v[188:191], v[220:223], v[148:151]
    v_and_b32 v243, 7, v242
    v_mfma_f32_16x16x32_bf16 v[156:159], v[184:187], v[220:223], v[156:159]
    v_xor_b32 v243, v243, v241
    v_mfma_f32_16x16x32_bf16 v[164:167], v[180:183], v[220:223], v[164:167]
    v_lshlrev_b32 v242, 7, v242
    v_mfma_f32_16x16x32_bf16 v[136:139], v[192:195], v[216:219], v[136:139]
    v_mfma_f32_16x16x32_bf16 v[144:147], v[188:191], v[216:219], v[144:147]
    v_mfma_f32_16x16x32_bf16 v[152:155], v[184:187], v[216:219], v[152:155]
    v_mfma_f32_16x16x32_bf16 v[160:163], v[180:183], v[216:219], v[160:163]
    s_waitcnt lgkmcnt(6)
    ds_read_b64 v[192:193], v248 offset:288
    ds_read_b64 v[194:195], v248 offset:296
    ds_read_b64 v[188:189], v248 offset:256
    ds_read_b64 v[190:191], v248 offset:264
    ds_read_b128 v[208:211], v234 offset:0
    ds_read_b128 v[212:215], v234 offset:2048
    v_mfma_f32_16x16x32_bf16 v[140:143], v[184:187], v[228:231], v[140:143]
    v_lshl_add_u32 v242, v243, 4, v242
    v_mfma_f32_16x16x32_bf16 v[148:151], v[180:183], v[228:231], v[148:151]
    v_add_u32 v232, s22, v242
    v_mfma_f32_16x16x32_bf16 v[156:159], v[176:179], v[228:231], v[156:159]
    v_xor_b32 v233, 64, v232
    v_mfma_f32_16x16x32_bf16 v[164:167], v[172:175], v[228:231], v[164:167]
    v_mfma_f32_16x16x32_bf16 v[136:139], v[184:187], v[224:227], v[136:139]
    v_mfma_f32_16x16x32_bf16 v[144:147], v[180:183], v[224:227], v[144:147]
    v_mfma_f32_16x16x32_bf16 v[152:155], v[176:179], v[224:227], v[152:155]
    v_mfma_f32_16x16x32_bf16 v[160:163], v[172:175], v[224:227], v[160:163]
    s_waitcnt lgkmcnt(6)
    ds_read_b64 v[184:185], v248 offset:224
    ds_read_b64 v[186:187], v248 offset:232
    ds_read_b64 v[180:181], v248 offset:192
    ds_read_b64 v[182:183], v248 offset:200
    ds_read_b128 v[216:219], v237 offset:0
    ds_read_b128 v[220:223], v237 offset:2048
    v_mfma_f32_16x16x32_bf16 v[140:143], v[176:179], v[204:207], v[140:143]
    v_subrev_u32 v242, 5, v240
    v_mfma_f32_16x16x32_bf16 v[148:151], v[172:175], v[204:207], v[148:151]
    v_and_b32 v243, 7, v242
    v_mfma_f32_16x16x32_bf16 v[156:159], v[168:171], v[204:207], v[156:159]
    v_xor_b32 v243, v243, v241
    v_mfma_f32_16x16x32_bf16 v[164:167], v[196:199], v[204:207], v[164:167]
    v_lshlrev_b32 v242, 7, v242
    v_mfma_f32_16x16x32_bf16 v[136:139], v[176:179], v[200:203], v[136:139]
    v_mfma_f32_16x16x32_bf16 v[144:147], v[172:175], v[200:203], v[144:147]
    v_mfma_f32_16x16x32_bf16 v[152:155], v[168:171], v[200:203], v[152:155]
    v_mfma_f32_16x16x32_bf16 v[160:163], v[196:199], v[200:203], v[160:163]
    s_waitcnt lgkmcnt(6)
    ds_read_b64 v[176:177], v248 offset:160
    ds_read_b64 v[178:179], v248 offset:168
    ds_read_b64 v[172:173], v248 offset:128
    ds_read_b64 v[174:175], v248 offset:136
    ds_read_b128 v[224:227], v236 offset:0
    ds_read_b128 v[228:231], v236 offset:2048
    v_mfma_f32_16x16x32_bf16 v[140:143], v[168:171], v[212:215], v[140:143]
    v_lshl_add_u32 v242, v243, 4, v242
    v_mfma_f32_16x16x32_bf16 v[148:151], v[196:199], v[212:215], v[148:151]
    v_add_u32 v234, s22, v242
    v_mfma_f32_16x16x32_bf16 v[156:159], v[192:195], v[212:215], v[156:159]
    v_xor_b32 v235, 64, v234
    v_mfma_f32_16x16x32_bf16 v[164:167], v[188:191], v[212:215], v[164:167]
    v_mfma_f32_16x16x32_bf16 v[136:139], v[168:171], v[208:211], v[136:139]
    v_mfma_f32_16x16x32_bf16 v[144:147], v[196:199], v[208:211], v[144:147]
    v_mfma_f32_16x16x32_bf16 v[152:155], v[192:195], v[208:211], v[152:155]
    v_mfma_f32_16x16x32_bf16 v[160:163], v[188:191], v[208:211], v[160:163]
    s_waitcnt lgkmcnt(6)
    ds_read_b64 v[168:169], v248 offset:96
    ds_read_b64 v[170:171], v248 offset:104
    ds_read_b64 v[196:197], v248 offset:64
    ds_read_b64 v[198:199], v248 offset:72
    ds_read_b128 v[200:203], v239 offset:0
    ds_read_b128 v[204:207], v239 offset:2048
    v_mfma_f32_16x16x32_bf16 v[140:143], v[192:195], v[220:223], v[140:143]
    v_subrev_u32 v242, 6, v240
    v_mfma_f32_16x16x32_bf16 v[148:151], v[188:191], v[220:223], v[148:151]
    v_and_b32 v243, 7, v242
    v_mfma_f32_16x16x32_bf16 v[156:159], v[184:187], v[220:223], v[156:159]
    v_xor_b32 v243, v243, v241
    v_mfma_f32_16x16x32_bf16 v[164:167], v[180:183], v[220:223], v[164:167]
    v_lshlrev_b32 v242, 7, v242
    v_mfma_f32_16x16x32_bf16 v[136:139], v[192:195], v[216:219], v[136:139]
    v_mfma_f32_16x16x32_bf16 v[144:147], v[188:191], v[216:219], v[144:147]
    v_mfma_f32_16x16x32_bf16 v[152:155], v[184:187], v[216:219], v[152:155]
    v_mfma_f32_16x16x32_bf16 v[160:163], v[180:183], v[216:219], v[160:163]
    s_waitcnt lgkmcnt(6)
    ds_read_b64 v[192:193], v248 offset:32
    ds_read_b64 v[194:195], v248 offset:40
    ds_read_b64 v[188:189], v248 offset:0
    ds_read_b64 v[190:191], v248 offset:8
    ds_read_b128 v[208:211], v238 offset:0
    ds_read_b128 v[212:215], v238 offset:2048
    v_mfma_f32_16x16x32_bf16 v[140:143], v[184:187], v[228:231], v[140:143]
    v_lshl_add_u32 v242, v243, 4, v242
    v_mfma_f32_16x16x32_bf16 v[148:151], v[180:183], v[228:231], v[148:151]
    v_add_u32 v236, s22, v242
    v_mfma_f32_16x16x32_bf16 v[156:159], v[176:179], v[228:231], v[156:159]
    v_xor_b32 v237, 64, v236
    v_mfma_f32_16x16x32_bf16 v[164:167], v[172:175], v[228:231], v[164:167]
    v_mfma_f32_16x16x32_bf16 v[136:139], v[184:187], v[224:227], v[136:139]
    v_mfma_f32_16x16x32_bf16 v[144:147], v[180:183], v[224:227], v[144:147]
    v_mfma_f32_16x16x32_bf16 v[152:155], v[176:179], v[224:227], v[152:155]
    v_mfma_f32_16x16x32_bf16 v[160:163], v[172:175], v[224:227], v[160:163]
    v_subrev_u32 v240, 4, v240
    v_subrev_u32 v248, 512, v248
    s_sub_u32 s63, s63, 1
    s_cmp_lg_u32 s63, 0
    s_cbranch_scc1 c_cv1
    s_mov_b32 s63, 4
c_cv2:
    s_waitcnt lgkmcnt(5)
    ds_read_b64 v[184:185], v248 offset:480
    ds_read_b64 v[186:187], v248 offset:488
    ds_read_b64 v[180:181], v248 offset:448
    ds_read_b64 v[182:183], v248 offset:456
    ds_read_b128 v[220:223], v233 offset:2048
    v_mfma_f32_16x16x32_bf16 v[140:143], v[176:179], v[204:207], v[140:143]
    v_subrev_u32 v242, 3, v240
    v_mfma_f32_16x16x32_bf16 v[148:151], v[172:175], v[204:207], v[148:151]
    v_and_b32 v243, 7, v242
    v_mfma_f32_16x16x32_bf16 v[156:159], v[168:171], v[204:207], v[156:159]
    v_xor_b32 v243, v243, v241
    v_mfma_f32_16x16x32_bf16 v[164:167], v[196:199], v[204:207], v[164:167]
    v_lshlrev_b32 v242, 7, v242
    s_waitcnt lgkmcnt(5)
    ds_read_b64 v[176:177], v248 offset:416
    ds_read_b64 v[178:179], v248 offset:424
    ds_read_b64 v[172:173], v248 offset:384
    ds_read_b64 v[174:175], v248 offset:392
    ds_read_b128 v[228:231], v232 offset:2048
    v_mfma_f32_16x16x32_bf16 v[140:143], v[168:171], v[212:215], v[140:143]
    v_lshl_add_u32 v242, v243, 4, v242
    v_mfma_f32_16x16x32_bf16 v[148:151], v[196:199], v[212:215], v[148:151]
    v_add_u32 v238, s22, v242
    v_mfma_f32_16x16x32_bf16 v[156:159], v[192:195], v[212:215], v[156:159]
    v_xor_b32 v239, 64, v238
    v_mfma_f32_16x16x32_bf16 v[164:167], v[188:191], v[212:215], v[164:167]
    s_waitcnt lgkmcnt(5)
    ds_read_b64 v[168:169], v248 offset:352
    ds_read_b64 v[170:171], v248 offset:360
    ds_read_b64 v[196:197], v248 offset:320
    ds_read_b64 v[198:199], v248 offset:328
    ds_read_b128 v[204:207], v235 offset:2048
    v_mfma_f32_16x16x32_bf16 v[140:143], v[192:195], v[220:223], v[140:143]
    v_subrev_u32 v242, 4, v240
    v_mfma_f32_16x16x32_bf16 v[148:151], v[188:191], v[220:223], v[148:151]
    v_and_b32 v243, 7, v242
    v_mfma_f32_16x16x32_bf16 v[156:159], v[184:187], v[220:223], v[156:159]
    v_xor_b32 v243, v243, v241
    v_mfma_f32_16x16x32_bf16 v[164:167], v[180:183], v[220:223], v[164:167]
    v_lshlrev_b32 v242, 7, v242
    s_waitcnt lgkmcnt(5)
    ds_read_b64 v[192:193], v248 offset:288
    ds_read_b64 v[194:195], v248 offset:296
    ds_read_b64 v[188:189], v248 offset:256
    ds_read_b64 v[190:191], v248 offset:264
    ds_read_b128 v[212:215], v234 offset:2048
    v_mfma_f32_16x16x32_bf16 v[140:143], v[184:187], v[228:231], v[140:143]
    v_lshl_add_u32 v242, v243, 4, v242
    v_mfma_f32_16x16x32_bf16 v[148:151], v[180:183], v[228:231], v[148:151]
    v_add_u32 v232, s22, v242
    v_mfma_f32_16x16x32_bf16 v[156:159], v[176:179], v[228:231], v[156:159]
    v_xor_b32 v233, 64, v232
    v_mfma_f32_16x16x32_bf16 v[164:167], v[172:175], v[228:231], v[164:167]
    s_waitcnt lgkmcnt(5)
    ds_read_b64 v[184:185], v248 offset:224
    ds_read_b64 v[186:187], v248 offset:232
    ds_read_b64 v[180:181], v248 offset:192
    ds_read_b64 v[182:183], v248 offset:200
    ds_read_b128 v[220:223], v237 offset:2048
    v_mfma_f32_16x16x32_bf16 v[140:143], v[176:179], v[204:207], v[140:143]
    v_subrev_u32 v242, 5, v240
    v_mfma_f32_16x16x32_bf16 v[148:151], v[172:175], v[204:207], v[148:151]
    v_and_b32 v243, 7, v242
    v_mfma_f32_16x16x32_bf16 v[156:159], v[168:171], v[204:207], v[156:159]
    v_xor_b32 v243, v243, v241
    v_mfma_f32_16x16x32_bf16 v[164:167], v[196:199], v[204:207], v[164:167]
    v_lshlrev_b32 v242, 7, v242
    s_waitcnt lgkmcnt(5)
    ds_read_b64 v[176:177], v248 offset:160
    ds_read_b64 v[178:179], v248 offset:168
    ds_read_b64 v[172:173], v248 offset:128
    ds_read_b64 v[174:175], v248 offset:136
    ds_read_b128 v[228:231], v236 offset:2048
    v_mfma_f32_16x16x32_bf16 v[140:143], v[168:171], v[212:215], v[140:143]
    v_lshl_add_u32 v242, v243, 4, v242
    v_mfma_f32_16x16x32_bf16 v[148:151], v[196:199], v[212:215], v[148:151]
    v_add_u32 v234, s22, v242
    v_mfma_f32_16x16x32_bf16 v[156:159], v[192:195], v[212:215], v[156:159]
    v_xor_b32 v235, 64, v234
    v_mfma_f32_16x16x32_bf16 v[164:167], v[188:191], v[212:215], v[164:167]
    s_waitcnt lgkmcnt(5)
    ds_read_b64 v[168:169], v248 offset:96
    ds_read_b64 v[170:171], v248 offset:104
    ds_read_b64 v[196:197], v248 offset:64
    ds_read_b64 v[198:199], v248 offset:72
    ds_read_b128 v[204:207], v239 offset:2048
    v_mfma_f32_16x16x32_bf16 v[140:143], v[192:195], v[220:223], v[140:143]
    v_subrev_u32 v242, 6, v240
    v_mfma_f32_16x16x32_bf16 v[148:151], v[188:191], v[220:223], v[148:151]
    v_and_b32 v243, 7, v242
    v_mfma_f32_16x16x32_bf16 v[156:159], v[184:187], v[220:223], v[156:159]
    v_xor_b32 v243, v243, v241
    v_mfma_f32_16x16x32_bf16 v[164:167], v[180:183], v[220:223], v[164:167]
    v_lshlrev_b32 v242, 7, v242
    s_waitcnt lgkmcnt(5)
    ds_read_b64 v[192:193], v248 offset:32
    ds_read_b64 v[194:195], v248 offset:40
    ds_read_b64 v[188:189], v248 offset:0
    ds_read_b64 v[190:191], v248 offset:8
    ds_read_b128 v[212:215], v238 offset:2048
    v_mfma_f32_16x16x32_bf16 v[140:143], v[184:187], v[228:231], v[140:143]
    v_lshl_add_u32 v242, v243, 4, v242
    v_mfma_f32_16x16x32_bf16 v[148:151], v[180:183], v[228:231], v[148:151]
    v_add_u32 v236, s22, v242
    v_mfma_f32_16x16x32_bf16 v[156:159], v[176:179], v[228:231], v[156:159]
    v_xor_b32 v237, 64, v236
    v_mfma_f32_16x16x32_bf16 v[164:167], v[172:175], v[228:231], v[164:167]
    v_subrev_u32 v240, 4, v240
    v_subrev_u32 v248, 512, v248
    s_sub_u32 s63, s63, 1
    s_cmp_lg_u32 s63, 0
    s_cbranch_scc1 c_cv2
    s_waitcnt lgkmcnt(0)
    v_and_b32 v44, 15, v1
    v_lshrrev_b32 v45, 4, v1
    v_lshrrev_b32 v46, 1, v45
    v_and_b32 v47, 7, v44
    v_xor_b32 v46, v46, v47
    v_lshlrev_b32 v46, 4, v46
    v_lshl_add_u32 v46, v44, 7, v46
    v_and_b32 v45, 1, v45
    v_lshl_add_u32 v46, v45, 3, v46
    v_add_u32 v124, s64, v46
    v_xor_b32 v125, 0, v124
    v_cvt_pk_bf16_f32 v48, v136, v137
    v_cvt_pk_bf16_f32 v49, v138, v139
    ds_write_b64 v125, v[48:49] offset:0
    v_cvt_pk_bf16_f32 v50, v140, v141
    v_cvt_pk_bf16_f32 v51, v142, v143
    ds_write_b64 v125, v[50:51] offset:2048
    v_xor_b32 v125, 32, v124
    v_cvt_pk_bf16_f32 v52, v144, v145
    v_cvt_pk_bf16_f32 v53, v146, v147
    ds_write_b64 v125, v[52:53] offset:0
    v_cvt_pk_bf16_f32 v54, v148, v149
    v_cvt_pk_bf16_f32 v55, v150, v151
    ds_write_b64 v125, v[54:55] offset:2048
    v_xor_b32 v125, 64, v124
    v_cvt_pk_bf16_f32 v56, v152, v153
    v_cvt_pk_bf16_f32 v57, v154, v155
    ds_write_b64 v125, v[56:57] offset:0
    v_cvt_pk_bf16_f32 v58, v156, v157
    v_cvt_pk_bf16_f32 v59, v158, v159
    ds_write_b64 v125, v[58:59] offset:2048
    v_xor_b32 v125, 96, v124
    v_cvt_pk_bf16_f32 v60, v160, v161
    v_cvt_pk_bf16_f32 v61, v162, v163
    ds_write_b64 v125, v[60:61] offset:0
    v_cvt_pk_bf16_f32 v62, v164, v165
    v_cvt_pk_bf16_f32 v63, v166, v167
    ds_write_b64 v125, v[62:63] offset:2048
    v_lshrrev_b32 v44, 3, v1
    v_and_b32 v45, 7, v1
    v_xor_b32 v45, v45, v44
    v_lshlrev_b32 v45, 4, v45
    v_lshl_add_u32 v45, v44, 7, v45
    v_add_u32 v45, s64, v45
    v_lshlrev_b32 v46, 4, v1
    s_mul_i32 s20, s60, 4224
    s_waitcnt lgkmcnt(0)
    ds_read_b128 v[168:171], v45 offset:0
    ds_read_b128 v[172:175], v45 offset:1024
    ds_read_b128 v[176:179], v45 offset:2048
    ds_read_b128 v[180:183], v45 offset:3072
    s_waitcnt lgkmcnt(3)
    buffer_store_dwordx4 v[168:171], v46, s[56:59], s20 offen offset:0 sc1
    s_waitcnt lgkmcnt(2)
    buffer_store_dwordx4 v[172:175], v46, s[56:59], s20 offen offset:1024 sc1
    s_waitcnt lgkmcnt(1)
    buffer_store_dwordx4 v[176:179], v46, s[56:59], s20 offen offset:2048 sc1
    s_waitcnt lgkmcnt(0)
    buffer_store_dwordx4 v[180:183], v46, s[56:59], s20 offen offset:3072 sc1
    s_waitcnt vmcnt(0)
    s_lshl_b32 s20, s60, 7
    s_add_u32 s20, s20, 65536
    v_mov_b32 v124, s70
    v_mov_b32 v125, 0
    s_mov_b64 exec, 1
    buffer_store_dword v124, v125, s[72:75], s20 offen sc1
    s_mov_b64 exec, -1
c_end:
k_end:
    s_endpgm

.section .rodata,"a"
.p2align 6
.amdhsa_kernel parallel_sum__ssm_conv_s4__glu_gated_swiglu__prompt_kernel
  .amdhsa_next_free_vgpr 256
  .amdhsa_next_free_sgpr 100
  .amdhsa_accum_offset 256
  .amdhsa_group_segment_fixed_size 0
  .amdhsa_kernarg_size 128
  .amdhsa_user_sgpr_count 2
  .amdhsa_user_sgpr_kernarg_segment_ptr 1
  .amdhsa_system_sgpr_workgroup_id_x 1
.end_amdhsa_kernel
```
